```python
import torch

def _softmax(x, axis=-1):
    return torch.softmax(x, dim=axis)
def _gelu(x):
    return torch.nn.functional.gelu(x, approximate="tanh")
def _silu(x):
    return torch.nn.functional.silu(x)
def _sigmoid(x):
    return torch.sigmoid(x)
def _layernorm(x, axis=-1, eps=1e-5):
    m = x.mean(dim=axis, keepdim=True)
    v = x.var(dim=axis, keepdim=True, unbiased=False)
    return (x - m) / torch.sqrt(v + eps)
def _scatter_add(tgt, idx, src, axis=0):
    return tgt.clone().index_add_(axis, idx, src)
def _segment_sum(src, seg, n):
    out = torch.zeros((n,) + src.shape[1:], dtype=src.dtype)
    return out.index_add_(0, seg, src)
def _pad(x, pw):
    flat = tuple(v for pair in reversed(pw) for v in pair)
    return torch.nn.functional.pad(x, flat)

kernel_name = 'sequential_preLN__mha_block_cached__glu_gated_glu__decode'

def setup_inputs():

    _w = (lambda a: (lambda t: t.to(torch.bfloat16) if t.is_floating_point() else t)(torch.as_tensor(a)))
    def _A_setup():
        B, Sq, D = 2, 1, 640
        H, Sk, Dh = 32, 4096, 192
        return {
            "x": _w((lambda *s: torch.randn(*s, dtype=torch.bfloat16) * 0.05)(B, Sq, D)),
            "k_cache": _w((lambda *s: torch.randn(*s, dtype=torch.bfloat16) * 3.2)(B, H, Sk, Dh)),
            "v_cache": _w((lambda *s: torch.randn(*s, dtype=torch.bfloat16) * 0.4)(B, H, Sk, Dh)),
            "wq": _w((lambda *s: torch.randn(*s, dtype=torch.bfloat16) * 3.2)(D, H * Dh) * (D ** -0.5)),
            "wo": _w((lambda *s: torch.randn(*s, dtype=torch.bfloat16) * 0.4)(H * Dh, D) * ((H * Dh) ** -0.5)),
        }
    _A_in = _A_setup()

    def _B_setup():
        B, S, D, F = 2, 1, 640, 1536
        return {
            "x": _w((lambda *s: torch.randn(*s, dtype=torch.bfloat16) * 0.05)(B, S, D)),
            "w_gate": _w((lambda *s: torch.randn(*s, dtype=torch.bfloat16) * 0.1)(D, F)),
            "w_up": _w((lambda *s: torch.randn(*s, dtype=torch.bfloat16) * 0.05)(D, F)),
            "w_down": _w((lambda *s: torch.randn(*s, dtype=torch.bfloat16) * 0.05)(F, D)),
        }
    _B_in = _B_setup()

    return {
        "A_x": _A_in["x"],
        "A_k_cache": _A_in["k_cache"],
        "A_v_cache": _A_in["v_cache"],
        "A_wq": _A_in["wq"],
        "A_wo": _A_in["wo"],
        "B_x": _B_in["x"],
        "B_w_gate": _B_in["w_gate"],
        "B_w_up": _B_in["w_up"],
        "B_w_down": _B_in["w_down"],
    }

def reference(A_x, A_k_cache, A_v_cache, A_wq, A_wo, B_x, B_w_gate, B_w_up, B_w_down):
    def _A_ref(x, k_cache, v_cache, wq, wo):
        B, Sq, D = x.shape
        H, Dh = 32, 192
        q = (lambda x, *d: x.permute(*d))((x @ wq).reshape(B, Sq, H, Dh), 0, 2, 1, 3)
        scores = torch.einsum("bhqd,bhkd->bhqk", q, k_cache) * (Dh ** -0.5)
        p = _softmax(scores, axis=-1)
        o = torch.einsum("bhqk,bhkd->bhqd", p, v_cache)
        return (lambda x, *d: x.permute(*d))(o, 0, 2, 1, 3).reshape(B, Sq, H * Dh) @ wo

    def _B_ref(x, w_gate, w_up, w_down):
        g = torch.einsum("bsd,df->bsf", x, w_gate)
        u = torch.einsum("bsd,df->bsf", x, w_up)
        h = _sigmoid(g) * u
        return torch.einsum("bsf,fd->bsd", h, w_down)

    x = A_x
    h = x + _A_ref(_layernorm(x, axis=-1), A_k_cache, A_v_cache, A_wq, A_wo)
    h2 = h + _B_ref(_layernorm(h, axis=-1), B_w_gate, B_w_up, B_w_down)
    return h2
```

```asm
; @launch grid=(256,1,1) block=(256,1,1) lds=127744
.amdgcn_target "amdgcn-amd-amdhsa--gfx950"
.text
.globl sequential_preLN__mha_block_cached__glu_gated_glu__decode_kernel
.p2align 8
.type sequential_preLN__mha_block_cached__glu_gated_glu__decode_kernel,@function
sequential_preLN__mha_block_cached__glu_gated_glu__decode_kernel:
    s_cmp_ge_u32 s2, 256
    s_cbranch_scc1 L_done
    s_load_dwordx2 s[28:29], s[0:1], 8
    s_load_dwordx16 s[4:19], s[0:1], 0
    s_load_dwordx8 s[20:27], s[0:1], 64
    s_and_b32 s64, s2, 63
    s_lshr_b32 s65, s2, 6
    v_lshrrev_b32 v8, 3, v0
    v_and_b32 v9, 7, v0
    v_mul_u32_u24 v2, 384, v8
    s_mul_i32 s71, s64, 1572864
    s_mul_i32 s72, s65, 12288
    v_lshlrev_b32 v7, 4, v9
    s_add_u32 s71, s71, s72
    s_mov_b32 s30, 100663296
    v_add3_u32 v2, v2, v7, s71
    s_mov_b32 s31, 0x20000
    s_mul_i32 s69, s64, 1
    s_and_b32 s69, s69, 31
    s_waitcnt lgkmcnt(0)
    s_mul_i32 s70, s69, 49152
    buffer_load_dwordx4 v[88:91], v2, s[28:31], s70 offen offset:0 nt
    buffer_load_dwordx4 v[92:95], v2, s[28:31], s70 offen offset:128 nt
    buffer_load_dwordx4 v[96:99], v2, s[28:31], s70 offen offset:256 nt
    v_lshrrev_b32 v10, 6, v0
    v_and_b32 v1, 63, v0
    v_readfirstlane_b32 s3, v10
    s_and_b32 s66, s64, 31
    s_lshr_b32 s67, s64, 5
    s_lshl_b32 s68, s67, 2
    s_add_u32 s68, s68, s65
    v_mul_u32_u24 v10, 40, v1
    s_mul_i32 s71, s68, 80
    v_add_u32 v11, s71, v8
    v_lshlrev_b32 v12, 1, v11
    v_mul_u32_u24 v13, 12288, v11
    v_add_u32 v13, v7, v13
    s_mul_i32 s72, s66, 384
    s_add_u32 s73, s72, 393216
    s_cmp_lt_u32 s3, 2
    s_cselect_b32 s74, 786432, 1073741824
    v_add_u32 v14, s74, v13
    v_lshrrev_b32 v18, 1, v1
    v_and_b32 v17, 1, v1
    v_lshlrev_b32 v18, 7, v18
    v_lshl_add_u32 v18, v17, 4, v18
    v_add_u32 v18, 786432, v18
    s_or_b32 s75, s2, s3
    s_cselect_b32 s75, 1073741824, 0
    v_add_u32 v15, s75, v18
    v_mov_b32 v48, -1
    v_mov_b32 v49, -1
    v_mov_b32 v50, -1
    v_mov_b32 v51, -1
    v_mul_u32_u24 v52, 4352, v1
    s_add_u32 s71, s75, 851968
    v_add_u32 v52, s71, v52
    s_mov_b32 s40, s4
    s_mov_b32 s41, s5
    s_mov_b32 s42, 2560
    s_mov_b32 s43, 0x20000
    s_mov_b32 s44, s26
    s_mov_b32 s45, s27
    s_mov_b32 s46, 4194304
    s_mov_b32 s47, 0x20000
    buffer_store_dwordx4 v[48:51], v15, s[44:47], 0 offen sc1
    buffer_store_dword v48, v52, s[44:47], 0 offen sc1
    buffer_load_dwordx4 v[32:35], v10, s[40:43], 0 offen
    buffer_load_dwordx4 v[36:39], v10, s[40:43], 0 offen offset:16
    buffer_load_dwordx2 v[40:41], v10, s[40:43], 0 offen offset:32
    s_mov_b32 s36, s10
    s_mov_b32 s37, s11
    s_mov_b32 s38, 7864320
    s_mov_b32 s39, 0x20000
    buffer_load_dwordx4 a[0:3], v13, s[36:39], s72 offen offset:0 nt
    buffer_load_dwordx4 a[4:7], v13, s[36:39], s72 offen offset:128 nt
    buffer_load_dwordx4 a[8:11], v13, s[36:39], s72 offen offset:256 nt
    buffer_load_ushort v42, v12, s[40:43], 0 offen offset:0
    buffer_load_ushort v43, v12, s[40:43], 0 offen offset:1280
    buffer_load_ushort v44, v12, s[40:43], 0 offen offset:64
    buffer_load_ushort v45, v12, s[40:43], 0 offen offset:1344
    buffer_load_ushort v46, v12, s[40:43], 0 offen offset:128
    buffer_load_ushort v47, v12, s[40:43], 0 offen offset:1408
    buffer_load_dwordx4 a[12:15], v13, s[36:39], s73 offen offset:0 nt
    buffer_load_dwordx4 a[16:19], v13, s[36:39], s73 offen offset:128 nt
    buffer_load_dwordx4 a[20:23], v13, s[36:39], s73 offen offset:256 nt
    buffer_load_dwordx4 a[24:27], v14, s[36:39], s72 offen offset:0 nt
    buffer_load_dwordx4 a[28:31], v14, s[36:39], s72 offen offset:128 nt
    buffer_load_dwordx4 a[32:35], v14, s[36:39], s72 offen offset:256 nt
    s_mov_b32 s32, s8
    s_mov_b32 s33, s9
    s_mov_b32 s34, 100663296
    s_mov_b32 s35, 0x20000
    s_mov_b32 s48, s24
    s_mov_b32 s49, s25
    s_mov_b32 s50, 256
    s_mov_b32 s51, 0x20000
    s_mul_i32 s71, s2, 1024
    s_add_u32 s71, s71, 524288
    v_lshl_add_u32 v15, v0, 4, s71
    v_cmp_gt_u32 vcc, 64, v0
    v_mov_b32 v16, 1073741824
    s_nop 0
    v_cndmask_b32 v15, v16, v15, vcc
    buffer_store_dwordx4 v[48:51], v15, s[44:47], 0 offen sc1
    s_lshl_b32 s71, s2, 4
    s_add_u32 s71, s71, 458752
    v_cmp_eq_u32 vcc, 16, v0
    v_mov_b32 v53, s71
    s_lshr_b32 s71, s2, 6
    s_lshl_b32 s71, s71, 14
    s_and_b32 s7, s2, 63
    s_lshl_b32 s7, s7, 7
    s_add_u32 s7, s7, s71
    s_add_u32 s7, s7, 393216
    s_xor_b32 s71, s7, 128
    v_lshl_add_u32 v54, v8, 13, s71
    v_lshl_add_u32 v54, v9, 4, v54
    v_cndmask_b32 v53, v54, v53, vcc
    v_cmp_gt_u32 vcc, 17, v0
    s_nop 1
    v_cndmask_b32 v53, v16, v53, vcc
    buffer_store_dwordx4 v[48:51], v53, s[44:47], 0 offen sc1
    s_getreg_b32 s38, hwreg(HW_REG_XCC_ID, 2, 1)
    v_lshlrev_b32 v17, 4, v17
    v_mov_b32 v7, 0xffff
    v_lshlrev_b32 v17, v17, v7
    v_lshrrev_b32 v7, 1, v9
    v_cmp_eq_u32 vcc, 0, v7
    s_nop 1
    v_cndmask_b32 v3, 0, v17, vcc
    v_cmp_eq_u32 vcc, 1, v7
    s_nop 1
    v_cndmask_b32 v4, 0, v17, vcc
    v_cmp_eq_u32 vcc, 2, v7
    s_nop 1
    v_cndmask_b32 v5, 0, v17, vcc
    v_cmp_eq_u32 vcc, 3, v7
    s_nop 1
    v_cndmask_b32 v6, 0, v17, vcc
    v_lshl_add_u32 v7, v1, 8, s75
    s_waitcnt vmcnt(17)
    buffer_store_dword v48, v7, s[48:51], 0 offen sc1
    s_add_u32 s70, s69, 1
    s_and_b32 s70, s70, 31
    s_mul_i32 s70, s70, 49152
    buffer_load_dwordx4 v[100:103], v2, s[28:31], s70 offen offset:0 nt
    buffer_load_dwordx4 v[104:107], v2, s[28:31], s70 offen offset:128 nt
    buffer_load_dwordx4 v[108:111], v2, s[28:31], s70 offen offset:256 nt
    v_lshlrev_b32 v208, 16, v32
    v_and_b32 v209, 0xffff0000, v32
    v_lshlrev_b32 v210, 16, v33
    v_and_b32 v211, 0xffff0000, v33
    v_lshlrev_b32 v212, 16, v34
    v_and_b32 v213, 0xffff0000, v34
    v_lshlrev_b32 v214, 16, v35
    v_and_b32 v215, 0xffff0000, v35
    v_lshlrev_b32 v216, 16, v36
    v_and_b32 v217, 0xffff0000, v36
    v_lshlrev_b32 v218, 16, v37
    v_and_b32 v219, 0xffff0000, v37
    v_lshlrev_b32 v220, 16, v38
    v_and_b32 v221, 0xffff0000, v38
    v_lshlrev_b32 v222, 16, v39
    v_and_b32 v223, 0xffff0000, v39
    v_lshlrev_b32 v224, 16, v40
    v_and_b32 v225, 0xffff0000, v40
    v_lshlrev_b32 v226, 16, v41
    v_and_b32 v227, 0xffff0000, v41
    v_add_f32 v228, v208, v209
    v_add_f32 v229, v210, v211
    v_add_f32 v228, v228, v212
    v_add_f32 v229, v229, v213
    v_add_f32 v228, v228, v214
    v_add_f32 v229, v229, v215
    v_add_f32 v228, v228, v216
    v_add_f32 v229, v229, v217
    v_add_f32 v228, v228, v218
    v_add_f32 v229, v229, v219
    v_add_f32 v228, v228, v220
    v_add_f32 v229, v229, v221
    v_add_f32 v228, v228, v222
    v_add_f32 v229, v229, v223
    v_add_f32 v228, v228, v224
    v_add_f32 v229, v229, v225
    v_add_f32 v228, v228, v226
    v_add_f32 v229, v229, v227
    v_add_f32 v228, v228, v229
    s_nop 1
    v_add_f32_dpp v228, v228, v228 quad_perm:[1,0,3,2] row_mask:0xf bank_mask:0xf
    s_nop 1
    v_add_f32_dpp v228, v228, v228 quad_perm:[2,3,0,1] row_mask:0xf bank_mask:0xf
    s_nop 1
    v_add_f32_dpp v228, v228, v228 row_half_mirror row_mask:0xf bank_mask:0xf
    s_nop 1
    v_add_f32_dpp v228, v228, v228 row_mirror row_mask:0xf bank_mask:0xf
    v_mov_b32 v229, v228
    s_nop 1
    v_permlane16_swap_b32 v228, v229
    v_add_f32 v228, v228, v229
    v_mul_f32 v230, 0x3acccccd, v228
    v_sub_f32 v208, v208, v230
    v_sub_f32 v209, v209, v230
    v_sub_f32 v210, v210, v230
    v_sub_f32 v211, v211, v230
    v_sub_f32 v212, v212, v230
    v_sub_f32 v213, v213, v230
    v_sub_f32 v214, v214, v230
    v_sub_f32 v215, v215, v230
    v_sub_f32 v216, v216, v230
    v_sub_f32 v217, v217, v230
    v_sub_f32 v218, v218, v230
    v_sub_f32 v219, v219, v230
    v_sub_f32 v220, v220, v230
    v_sub_f32 v221, v221, v230
    v_sub_f32 v222, v222, v230
    v_sub_f32 v223, v223, v230
    v_sub_f32 v224, v224, v230
    v_sub_f32 v225, v225, v230
    v_sub_f32 v226, v226, v230
    v_sub_f32 v227, v227, v230
    v_mul_f32 v228, v208, v208
    v_mul_f32 v229, v209, v209
    v_fmac_f32 v228, v210, v210
    v_fmac_f32 v229, v211, v211
    v_fmac_f32 v228, v212, v212
    v_fmac_f32 v229, v213, v213
    v_fmac_f32 v228, v214, v214
    v_fmac_f32 v229, v215, v215
    v_fmac_f32 v228, v216, v216
    v_fmac_f32 v229, v217, v217
    v_fmac_f32 v228, v218, v218
    v_fmac_f32 v229, v219, v219
    v_fmac_f32 v228, v220, v220
    v_fmac_f32 v229, v221, v221
    v_fmac_f32 v228, v222, v222
    v_fmac_f32 v229, v223, v223
    v_fmac_f32 v228, v224, v224
    v_fmac_f32 v229, v225, v225
    v_fmac_f32 v228, v226, v226
    v_fmac_f32 v229, v227, v227
    v_add_f32 v228, v228, v229
    s_nop 1
    v_add_f32_dpp v228, v228, v228 quad_perm:[1,0,3,2] row_mask:0xf bank_mask:0xf
    s_nop 1
    v_add_f32_dpp v228, v228, v228 quad_perm:[2,3,0,1] row_mask:0xf bank_mask:0xf
    s_nop 1
    v_add_f32_dpp v228, v228, v228 row_half_mirror row_mask:0xf bank_mask:0xf
    s_nop 1
    v_add_f32_dpp v228, v228, v228 row_mirror row_mask:0xf bank_mask:0xf
    v_mov_b32 v229, v228
    s_nop 1
    v_permlane16_swap_b32 v228, v229
    v_add_f32 v228, v228, v229
    v_mul_f32 v228, 0x3acccccd, v228
    v_cvt_pk_bf16_f32 v228, 0, v228
    v_add_f32 v228, 0x3727c5ac, v228
    v_cvt_pk_bf16_f32 v228, 0, v228
    v_sqrt_f32 v228, v228
    v_cvt_pk_bf16_f32 v230, 0, v230
    v_cvt_pk_bf16_f32 v228, 0, v228
    v_rcp_f32 v228, v228
    v_readlane_b32 s76, v230, 0
    v_readlane_b32 s77, v230, 32
    v_readlane_b32 s78, v228, 0
    v_readlane_b32 s79, v228, 32
    s_add_u32 s70, s69, 2
    s_and_b32 s70, s70, 31
    s_mul_i32 s70, s70, 49152
    buffer_load_dwordx4 v[112:115], v2, s[28:31], s70 offen offset:0 nt
    buffer_load_dwordx4 v[116:119], v2, s[28:31], s70 offen offset:128 nt
    s_waitcnt vmcnt(14)
    v_lshlrev_b32 v42, 16, v42
    v_lshlrev_b32 v43, 16, v43
    v_lshlrev_b32 v44, 16, v44
    v_lshlrev_b32 v45, 16, v45
    v_lshlrev_b32 v46, 16, v46
    v_lshlrev_b32 v47, 16, v47
    v_subrev_f32 v42, s76, v42
    v_subrev_f32 v43, s77, v43
    v_subrev_f32 v44, s76, v44
    v_subrev_f32 v45, s77, v45
    v_subrev_f32 v46, s76, v46
    v_subrev_f32 v47, s77, v47
    v_cvt_pk_bf16_f32 v42, 0, v42
    v_cvt_pk_bf16_f32 v43, 0, v43
    v_cvt_pk_bf16_f32 v44, 0, v44
    v_cvt_pk_bf16_f32 v45, 0, v45
    v_cvt_pk_bf16_f32 v46, 0, v46
    v_cvt_pk_bf16_f32 v47, 0, v47
    v_mul_f32 v42, s78, v42
    v_mul_f32 v43, s79, v43
    v_mul_f32 v44, s78, v44
    v_mul_f32 v45, s79, v45
    v_mul_f32 v46, s78, v46
    v_mul_f32 v47, s79, v47
    v_cvt_pk_bf16_f32 v42, v42, v42
    v_cvt_pk_bf16_f32 v43, v43, v43
    v_cvt_pk_bf16_f32 v44, v44, v44
    v_cvt_pk_bf16_f32 v45, v45, v45
    v_cvt_pk_bf16_f32 v46, v46, v46
    v_cvt_pk_bf16_f32 v47, v47, v47
    v_and_b32 v232, v42, v3
    v_and_b32 v233, v42, v4
    v_and_b32 v234, v42, v5
    v_and_b32 v235, v42, v6
    v_and_b32 v236, v43, v3
    v_and_b32 v237, v43, v4
    v_and_b32 v238, v43, v5
    v_and_b32 v239, v43, v6
    v_and_b32 v240, v44, v3
    v_and_b32 v241, v44, v4
    v_and_b32 v242, v44, v5
    v_and_b32 v243, v44, v6
    v_and_b32 v244, v45, v3
    v_and_b32 v245, v45, v4
    v_and_b32 v246, v45, v5
    v_and_b32 v247, v45, v6
    v_and_b32 v248, v46, v3
    v_and_b32 v249, v46, v4
    v_and_b32 v250, v46, v5
    v_and_b32 v251, v46, v6
    v_and_b32 v252, v47, v3
    v_and_b32 v253, v47, v4
    v_and_b32 v254, v47, v5
    v_and_b32 v255, v47, v6
    v_mfma_f32_16x16x32_bf16 v[208:211], v[232:235], a[0:3], 0
    v_mfma_f32_16x16x32_bf16 v[212:215], v[232:235], a[4:7], 0
    v_mfma_f32_16x16x32_bf16 v[216:219], v[232:235], a[8:11], 0
    v_mfma_f32_16x16x32_bf16 v[220:223], v[236:239], a[0:3], 0
    v_mfma_f32_16x16x32_bf16 v[224:227], v[236:239], a[4:7], 0
    v_mfma_f32_16x16x32_bf16 v[228:231], v[236:239], a[8:11], 0
    s_waitcnt vmcnt(11)
    buffer_load_dwordx4 v[120:123], v2, s[28:31], s70 offen offset:256 nt
    v_mfma_f32_16x16x32_bf16 v[208:211], v[240:243], a[12:15], v[208:211]
    v_mfma_f32_16x16x32_bf16 v[212:215], v[240:243], a[16:19], v[212:215]
    v_mfma_f32_16x16x32_bf16 v[216:219], v[240:243], a[20:23], v[216:219]
    v_mfma_f32_16x16x32_bf16 v[220:223], v[244:247], a[12:15], v[220:223]
    v_mfma_f32_16x16x32_bf16 v[224:227], v[244:247], a[16:19], v[224:227]
    v_mfma_f32_16x16x32_bf16 v[228:231], v[244:247], a[20:23], v[228:231]
    s_waitcnt vmcnt(9)
    s_add_u32 s70, s69, 3
    s_and_b32 s70, s70, 31
    s_mul_i32 s70, s70, 49152
    buffer_load_dwordx4 v[124:127], v2, s[28:31], s70 offen offset:0 nt
    buffer_load_dwordx4 v[128:131], v2, s[28:31], s70 offen offset:128 nt
    v_mfma_f32_16x16x32_bf16 v[208:211], v[248:251], a[24:27], v[208:211]
    v_mfma_f32_16x16x32_bf16 v[212:215], v[248:251], a[28:31], v[212:215]
    v_mfma_f32_16x16x32_bf16 v[216:219], v[248:251], a[32:35], v[216:219]
    v_mfma_f32_16x16x32_bf16 v[220:223], v[252:255], a[24:27], v[220:223]
    v_mfma_f32_16x16x32_bf16 v[224:227], v[252:255], a[28:31], v[224:227]
    v_mfma_f32_16x16x32_bf16 v[228:231], v[252:255], a[32:35], v[228:231]
    v_lshrrev_b32 v11, 5, v1
    v_and_b32 v10, 16, v1
    v_lshl_add_u32 v10, v9, 5, v10
    v_mul_u32_u24 v12, 1536, v11
    s_mul_i32 s71, s3, 3072
    v_add3_u32 v12, v12, v10, s71
    s_lshl_b32 s71, s3, 11
    v_lshl_add_u32 v19, v11, 10, v10
    v_add_u32 v19, s71, v19
    s_mov_b32 exec_lo, 0xff00ff
    s_mov_b32 exec_hi, 0xff00ff00
    ds_write_b128 v12, v[208:211] offset:0
    ds_write_b128 v12, v[212:215] offset:256
    ds_write_b128 v12, v[216:219] offset:512
    ds_write_b128 v12, v[220:223] offset:768
    ds_write_b128 v12, v[224:227] offset:1024
    ds_write_b128 v12, v[228:231] offset:1280
    s_mov_b64 exec, -1
    s_waitcnt vmcnt(10)
    buffer_load_dwordx4 v[132:135], v2, s[28:31], s70 offen offset:256 nt
    s_add_u32 s70, s69, 4
    s_and_b32 s70, s70, 31
    s_mul_i32 s70, s70, 49152
    s_waitcnt vmcnt(10)
    buffer_load_dwordx4 v[136:139], v2, s[28:31], s70 offen offset:0 nt
    s_waitcnt vmcnt(10)
    buffer_load_dwordx4 v[140:143], v2, s[28:31], s70 offen offset:128 nt
    s_waitcnt lgkmcnt(0)
    s_barrier
    v_lshlrev_b32 v11, 4, v1
    s_cmp_lg_u32 s3, 0
    s_cbranch_scc1 L_qnored
    ds_read_b128 v[32:35], v11 offset:0
    ds_read_b128 v[36:39], v11 offset:1536
    ds_read_b128 v[40:43], v11 offset:3072
    ds_read_b128 v[44:47], v11 offset:4608
    ds_read_b128 v[48:51], v11 offset:6144
    ds_read_b128 v[52:55], v11 offset:7680
    ds_read_b128 v[56:59], v11 offset:9216
    ds_read_b128 v[60:63], v11 offset:10752
    ds_read_b128 v[208:211], v11 offset:768
    ds_read_b128 v[212:215], v11 offset:2304
    ds_read_b128 v[216:219], v11 offset:3840
    ds_read_b128 v[220:223], v11 offset:5376
    ds_read_b128 v[224:227], v11 offset:6912
    ds_read_b128 v[228:231], v11 offset:8448
    ds_read_b128 v[232:235], v11 offset:9984
    ds_read_b128 v[236:239], v11 offset:11520
    s_waitcnt lgkmcnt(8)
    v_pk_add_f32 v[32:33], v[32:33], v[48:49]
    v_pk_add_f32 v[34:35], v[34:35], v[50:51]
    v_pk_add_f32 v[36:37], v[36:37], v[52:53]
    v_pk_add_f32 v[38:39], v[38:39], v[54:55]
    v_pk_add_f32 v[40:41], v[40:41], v[56:57]
    v_pk_add_f32 v[42:43], v[42:43], v[58:59]
    v_pk_add_f32 v[44:45], v[44:45], v[60:61]
    v_pk_add_f32 v[46:47], v[46:47], v[62:63]
    v_pk_add_f32 v[32:33], v[32:33], v[40:41]
    v_pk_add_f32 v[34:35], v[34:35], v[42:43]
    v_pk_add_f32 v[36:37], v[36:37], v[44:45]
    v_pk_add_f32 v[38:39], v[38:39], v[46:47]
    v_pk_add_f32 v[32:33], v[32:33], v[36:37]
    v_pk_add_f32 v[34:35], v[34:35], v[38:39]
    s_waitcnt lgkmcnt(0)
    v_pk_add_f32 v[208:209], v[208:209], v[224:225]
    v_pk_add_f32 v[210:211], v[210:211], v[226:227]
    v_pk_add_f32 v[212:213], v[212:213], v[228:229]
    v_pk_add_f32 v[214:215], v[214:215], v[230:231]
    v_pk_add_f32 v[216:217], v[216:217], v[232:233]
    v_pk_add_f32 v[218:219], v[218:219], v[234:235]
    v_pk_add_f32 v[220:221], v[220:221], v[236:237]
    v_pk_add_f32 v[222:223], v[222:223], v[238:239]
    v_pk_add_f32 v[208:209], v[208:209], v[216:217]
    v_pk_add_f32 v[210:211], v[210:211], v[218:219]
    v_pk_add_f32 v[212:213], v[212:213], v[220:221]
    v_pk_add_f32 v[214:215], v[214:215], v[222:223]
    v_pk_add_f32 v[208:209], v[208:209], v[212:213]
    v_pk_add_f32 v[210:211], v[210:211], v[214:215]
L_qnored:
    s_lshl_b32 s71, s66, 3
    s_add_u32 s71, s71, s68
    s_mul_i32 s71, s71, 1536
    v_cmp_gt_u32 vcc, 48, v0
    v_add_u32 v11, s71, v11
    s_nop 0
    v_cndmask_b32 v11, v16, v11, vcc
    buffer_store_dwordx4 v[32:35], v11, s[44:47], 0 offen offset:0 sc1
    buffer_store_dwordx4 v[208:211], v11, s[44:47], 0 offen offset:768 sc1
    buffer_load_dword v12, off, s[48:51], 0 sc1
    s_lshl_b32 s71, s66, 7
    s_lshl_b32 s72, s68, 2
    s_add_u32 s71, s71, 786432
    s_add_u32 s72, s72, s71
    v_cmp_eq_u32 vcc, 0, v0
    v_mov_b32 v11, s72
    v_mov_b32 v13, 1
    v_cndmask_b32 v11, v16, v11, vcc
    s_mov_b32 s6, 0
    s_cmp_lg_u32 s3, 0
    s_cbranch_scc1 L_novote
    s_buffer_load_dword s8, s[44:47], s7
    s_buffer_load_dwordx2 s[4:5], s[44:47], s7 offset:8192
L_novote:
    s_waitcnt vmcnt(8)
    buffer_load_dwordx4 v[144:147], v2, s[28:31], s70 offen offset:256 nt
    s_getreg_b32 s9, hwreg(HW_REG_IB_STS, 8, 2)
    s_bitcmp1_b32 s9, 0
    s_addc_u32 s6, s6, 0
    s_bitcmp1_b32 s9, 1
    s_subb_u32 s6, s6, 0
    s_add_u32 s70, s69, 5
    s_and_b32 s70, s70, 31
    s_mul_i32 s70, s70, 49152
    s_waitcnt vmcnt(8)
    buffer_load_dwordx4 v[148:151], v2, s[28:31], s70 offen offset:0 nt
    s_getreg_b32 s9, hwreg(HW_REG_IB_STS, 8, 2)
    s_bitcmp1_b32 s9, 0
    s_addc_u32 s6, s6, 0
    s_bitcmp1_b32 s9, 1
    s_subb_u32 s6, s6, 0
    s_waitcnt vmcnt(8)
    buffer_load_dwordx4 v[152:155], v2, s[28:31], s70 offen offset:128 nt
    s_getreg_b32 s9, hwreg(HW_REG_IB_STS, 8, 2)
    s_bitcmp1_b32 s9, 0
    s_addc_u32 s6, s6, 0
    s_bitcmp1_b32 s9, 1
    s_subb_u32 s6, s6, 0
    s_waitcnt vmcnt(8)
    buffer_load_dwordx4 v[156:159], v2, s[28:31], s70 offen offset:256 nt
    s_getreg_b32 s9, hwreg(HW_REG_IB_STS, 8, 2)
    s_bitcmp1_b32 s9, 0
    s_addc_u32 s6, s6, 0
    s_bitcmp1_b32 s9, 1
    s_subb_u32 s6, s6, 0
    s_add_u32 s70, s69, 6
    s_and_b32 s70, s70, 31
    s_mul_i32 s70, s70, 49152
    s_waitcnt vmcnt(8)
    buffer_load_dwordx4 v[160:163], v2, s[28:31], s70 offen offset:0 nt
    s_getreg_b32 s9, hwreg(HW_REG_IB_STS, 8, 2)
    s_bitcmp1_b32 s9, 0
    s_addc_u32 s6, s6, 0
    s_bitcmp1_b32 s9, 1
    s_subb_u32 s6, s6, 0
    s_waitcnt vmcnt(8)
    buffer_load_dwordx4 v[164:167], v2, s[28:31], s70 offen offset:128 nt
    s_getreg_b32 s9, hwreg(HW_REG_IB_STS, 8, 2)
    s_bitcmp1_b32 s9, 0
    s_addc_u32 s6, s6, 0
    s_bitcmp1_b32 s9, 1
    s_subb_u32 s6, s6, 0
    s_waitcnt vmcnt(8)
    buffer_load_dwordx4 v[168:171], v2, s[28:31], s70 offen offset:256 nt
    s_getreg_b32 s9, hwreg(HW_REG_IB_STS, 8, 2)
    s_bitcmp1_b32 s9, 0
    s_addc_u32 s6, s6, 0
    s_bitcmp1_b32 s9, 1
    s_subb_u32 s6, s6, 0
    s_add_u32 s70, s69, 7
    s_and_b32 s70, s70, 31
    s_mul_i32 s70, s70, 49152
    s_waitcnt vmcnt(8)
    buffer_load_dwordx4 v[172:175], v2, s[28:31], s70 offen offset:0 nt
    s_getreg_b32 s9, hwreg(HW_REG_IB_STS, 8, 2)
    s_bitcmp1_b32 s9, 0
    s_addc_u32 s6, s6, 0
    s_bitcmp1_b32 s9, 1
    s_subb_u32 s6, s6, 0
    s_waitcnt vmcnt(8)
    buffer_load_dwordx4 v[176:179], v2, s[28:31], s70 offen offset:128 nt
    s_getreg_b32 s9, hwreg(HW_REG_IB_STS, 8, 2)
    s_bitcmp1_b32 s9, 0
    s_addc_u32 s6, s6, 0
    s_bitcmp1_b32 s9, 1
    s_subb_u32 s6, s6, 0
    s_min_i32 s6, s6, 2
    s_max_i32 s6, s6, -2
    s_lshl1_add_u32 s9, s38, -1
    s_mul_i32 s6, s6, s9
    s_add_u32 s6, s6, 16
    v_mov_b32 v13, s6
    v_cmp_ne_u32 vcc, -1, v12
    s_mov_b32 s75, 0
    s_cbranch_vccz L_btok
L_btspin:
    buffer_load_dword v12, off, s[48:51], 0 sc1
    s_add_u32 s75, s75, 1
    s_waitcnt vmcnt(0)
    v_cmp_ne_u32 vcc, -1, v12
    s_cbranch_vccz L_btok
    s_cmp_lt_u32 s75, 4194304
    s_cbranch_scc1 L_btspin
L_btok:
    buffer_store_dword v13, v11, s[44:47], 0 offen sc1
    v_lshl_add_u32 v11, v9, 2, s71
    s_waitcnt vmcnt(7)
    buffer_load_dwordx4 v[180:183], v2, s[28:31], s70 offen offset:256 nt
    s_add_u32 s70, s69, 8
    s_and_b32 s70, s70, 31
    s_mul_i32 s70, s70, 49152
    s_waitcnt vmcnt(7)
    buffer_load_dwordx4 v[184:187], v2, s[28:31], s70 offen offset:0 nt
    s_waitcnt vmcnt(7)
    buffer_load_dwordx4 v[188:191], v2, s[28:31], s70 offen offset:128 nt
    s_waitcnt vmcnt(7)
    buffer_load_dwordx4 v[192:195], v2, s[28:31], s70 offen offset:256 nt
    s_add_u32 s70, s69, 9
    s_and_b32 s70, s70, 31
    s_mul_i32 s70, s70, 49152
    s_waitcnt vmcnt(7)
    buffer_load_dwordx4 v[196:199], v2, s[28:31], s70 offen offset:0 nt
    s_waitcnt vmcnt(7)
    buffer_load_dwordx4 v[200:203], v2, s[28:31], s70 offen offset:128 nt
    s_waitcnt vmcnt(7)
    buffer_load_dwordx4 v[204:207], v2, s[28:31], s70 offen offset:256 nt
    s_add_u32 s70, s69, 10
    s_and_b32 s70, s70, 31
    s_mul_i32 s70, s70, 49152
    s_waitcnt vmcnt(7)
    buffer_load_dwordx4 v[208:211], v2, s[28:31], s70 offen offset:0 nt
    s_waitcnt vmcnt(4)
    buffer_load_dwordx4 v[212:215], v2, s[28:31], s70 offen offset:128 nt
    s_waitcnt vmcnt(4)
    buffer_load_dwordx4 v[216:219], v2, s[28:31], s70 offen offset:256 nt
    s_add_u32 s70, s69, 11
    s_and_b32 s70, s70, 31
    s_mul_i32 s70, s70, 49152
    s_waitcnt vmcnt(4)
    buffer_load_dwordx4 v[220:223], v2, s[28:31], s70 offen offset:0 nt
    s_waitcnt vmcnt(4)
    buffer_load_dwordx4 v[224:227], v2, s[28:31], s70 offen offset:128 nt
    s_waitcnt vmcnt(4)
    buffer_load_dwordx4 v[228:231], v2, s[28:31], s70 offen offset:256 nt
    s_add_u32 s70, s69, 12
    s_and_b32 s70, s70, 31
    s_mul_i32 s70, s70, 49152
    s_waitcnt vmcnt(4)
    buffer_load_dwordx4 v[232:235], v2, s[28:31], s70 offen offset:0 nt
    s_waitcnt vmcnt(4)
    buffer_load_dwordx4 v[236:239], v2, s[28:31], s70 offen offset:128 nt
    s_waitcnt vmcnt(4)
    buffer_load_dwordx4 v[240:243], v2, s[28:31], s70 offen offset:256 nt
    s_add_u32 s70, s69, 13
    s_and_b32 s70, s70, 31
    s_mul_i32 s70, s70, 49152
    s_waitcnt vmcnt(4)
    buffer_load_dwordx4 v[244:247], v2, s[28:31], s70 offen offset:0 nt
    s_waitcnt vmcnt(4)
    buffer_load_dwordx4 v[248:251], v2, s[28:31], s70 offen offset:128 nt
    s_waitcnt vmcnt(4)
    buffer_load_dwordx4 v[252:255], v2, s[28:31], s70 offen offset:256 nt
    buffer_load_dword v12, v11, s[44:47], 0 offen sc1
    s_lshl_b32 s71, s66, 3
    s_lshl_b32 s72, s3, 1
    s_add_u32 s71, s71, s72
    s_mul_i32 s71, s71, 1536
    s_mul_i32 s72, s67, 768
    s_add_u32 s71, s71, s72
    v_cmp_gt_u32 vcc, 48, v1
    v_lshl_add_u32 v13, v1, 4, s71
    s_mov_b32 s75, 0
    v_cndmask_b32 v13, v16, v13, vcc
    s_add_u32 s70, s69, 14
    s_and_b32 s70, s70, 31
    s_mul_i32 s70, s70, 49152
    s_waitcnt vmcnt(5)
    buffer_load_dwordx4 a[156:159], v2, s[28:31], s70 offen offset:0 nt
    s_waitcnt vmcnt(5)
    buffer_load_dwordx4 a[160:163], v2, s[28:31], s70 offen offset:128 nt
    s_waitcnt vmcnt(5)
    buffer_load_dwordx4 a[164:167], v2, s[28:31], s70 offen offset:256 nt
    s_add_u32 s70, s69, 15
    s_and_b32 s70, s70, 31
    s_mul_i32 s70, s70, 49152
    s_waitcnt vmcnt(5)
    buffer_load_dwordx4 a[168:171], v2, s[28:31], s70 offen offset:0 nt
    s_waitcnt vmcnt(5)
    buffer_load_dwordx4 a[172:175], v2, s[28:31], s70 offen offset:128 nt
    s_waitcnt vmcnt(5)
    buffer_load_dwordx4 a[176:179], v2, s[28:31], s70 offen offset:256 nt
    v_cmp_eq_u32 vcc, -1, v12
    s_mov_b32 s75, 0
    s_cbranch_vccz L_flok
L_flspin:
    buffer_load_dword v12, v11, s[44:47], 0 offen sc1
    s_add_u32 s75, s75, 1
    s_waitcnt vmcnt(0)
    v_cmp_eq_u32 vcc, -1, v12
    s_cbranch_vccz L_flok
    s_cmp_lt_u32 s75, 4194304
    s_cbranch_scc1 L_flspin
L_flok:
    buffer_load_dwordx4 v[32:35], v13, s[44:47], 0 offen offset:0 sc1
    buffer_load_dwordx4 v[36:39], v13, s[44:47], 0 offen offset:1536 sc1
    v_lshlrev_b32 v11, 4, v1
    s_mul_i32 s71, s3, 768
    v_add_u32 v12, s71, v11
    s_mul_i32 s71, s3, 384
    v_lshl_add_u32 v13, v1, 3, s71
    v_lshl_add_u32 v14, v9, 4, s71
    s_add_u32 s70, s69, 16
    s_and_b32 s70, s70, 31
    s_mul_i32 s70, s70, 49152
    s_waitcnt vmcnt(5)
    buffer_load_dwordx4 a[180:183], v2, s[28:31], s70 offen offset:0 nt
    s_waitcnt vmcnt(5)
    buffer_load_dwordx4 a[184:187], v2, s[28:31], s70 offen offset:128 nt
    s_waitcnt vmcnt(5)
    buffer_load_dwordx4 a[188:191], v2, s[28:31], s70 offen offset:256 nt
    s_add_u32 s70, s69, 17
    s_and_b32 s70, s70, 31
    s_mul_i32 s70, s70, 49152
    s_waitcnt vmcnt(5)
    buffer_load_dwordx4 a[192:195], v2, s[28:31], s70 offen offset:0 nt
    s_waitcnt vmcnt(5)
    buffer_load_dwordx4 a[196:199], v2, s[28:31], s70 offen offset:128 nt
    s_waitcnt vmcnt(5)
    buffer_load_dwordx4 a[200:203], v2, s[28:31], s70 offen offset:256 nt
    v_pk_add_f32 v[32:33], v[32:33], v[36:37]
    v_pk_add_f32 v[34:35], v[34:35], v[38:39]
    s_mov_b32 exec_lo, 0xffffffff
    s_mov_b32 exec_hi, 0xffff
    ds_write_b128 v12, v[32:35] offset:12288
    s_mov_b64 exec, -1
    s_lshl_b32 s57, s3, 2
    v_mov_b32 v17, s57
    v_mov_b32 v86, 0
    ds_write_b32 v17, v86 offset:16944
    s_mov_b32 s56, 0
    s_lshr_b32 s57, s2, 3
    s_lshr_b32 s58, s2, 5
    s_add_u32 s57, s57, s58
    s_and_b32 s57, s57, 3
    s_mul_i32 s57, s57, 4352
    s_add_u32 s57, s57, 851968
    v_cmp_eq_u32 vcc, 0, v0
    v_mov_b32 v87, s57
    s_nop 0
    v_cndmask_b32 v87, v16, v87, vcc
    s_add_u32 s70, s69, 18
    s_and_b32 s70, s70, 31
    s_mul_i32 s70, s70, 49152
    buffer_load_dwordx4 a[204:207], v2, s[28:31], s70 offen offset:0 nt
    buffer_load_dwordx4 a[208:211], v2, s[28:31], s70 offen offset:128 nt
    s_mov_b32 exec_lo, 0xffffffff
    s_mov_b32 exec_hi, 0xffff
    s_waitcnt lgkmcnt(0)
    s_barrier
    ds_read_b128 v[32:35], v11 offset:12288
    ds_read_b128 v[36:39], v11 offset:13056
    ds_read_b128 v[40:43], v11 offset:13824
    ds_read_b128 v[44:47], v11 offset:14592
    s_waitcnt lgkmcnt(0)
    v_pk_add_f32 v[32:33], v[32:33], v[40:41]
    v_pk_add_f32 v[34:35], v[34:35], v[42:43]
    v_pk_add_f32 v[36:37], v[36:37], v[44:45]
    v_pk_add_f32 v[38:39], v[38:39], v[46:47]
    v_pk_add_f32 v[32:33], v[32:33], v[36:37]
    v_pk_add_f32 v[34:35], v[34:35], v[38:39]
    v_cvt_pk_bf16_f32 v32, v32, v33
    v_cvt_pk_bf16_f32 v33, v34, v35
    ds_write_b64 v13, v[32:33] offset:15360
    s_mov_b64 exec, -1
    s_waitcnt lgkmcnt(0)
    ds_read_b128 v[20:23], v14 offset:15360
    ds_read_b128 v[24:27], v14 offset:15488
    ds_read_b128 v[28:31], v14 offset:15616
    s_mov_b32 s74, 0x3d93cd3a
    s_waitcnt lgkmcnt(0)
    s_mov_b32 s76, 0x3fb8aa3b
    v_mov_b32 v14, 0
    s_waitcnt vmcnt(4)
    buffer_load_dwordx4 a[212:215], v2, s[28:31], s70 offen offset:256 nt
    v_dot2_f32_bf16 v32, v88, v20, 0
    v_dot2_f32_bf16 v32, v89, v21, v32
    v_dot2_f32_bf16 v32, v90, v22, v32
    v_dot2_f32_bf16 v32, v91, v23, v32
    v_dot2_f32_bf16 v32, v92, v24, v32
    v_dot2_f32_bf16 v32, v93, v25, v32
    v_dot2_f32_bf16 v32, v94, v26, v32
    v_dot2_f32_bf16 v32, v95, v27, v32
    v_dot2_f32_bf16 v32, v96, v28, v32
    v_dot2_f32_bf16 v32, v97, v29, v32
    v_dot2_f32_bf16 v32, v98, v30, v32
    v_dot2_f32_bf16 v32, v99, v31, v32
    v_dot2_f32_bf16 v33, v100, v20, 0
    v_dot2_f32_bf16 v33, v101, v21, v33
    v_dot2_f32_bf16 v33, v102, v22, v33
    v_add_f32_dpp v32, v32, v32 quad_perm:[1,0,3,2] row_mask:0xf bank_mask:0xf
    v_dot2_f32_bf16 v33, v103, v23, v33
    v_dot2_f32_bf16 v33, v104, v24, v33
    v_add_f32_dpp v32, v32, v32 quad_perm:[2,3,0,1] row_mask:0xf bank_mask:0xf
    v_dot2_f32_bf16 v33, v105, v25, v33
    v_dot2_f32_bf16 v33, v106, v26, v33
    v_add_f32_dpp v32, v32, v32 row_half_mirror row_mask:0xf bank_mask:0xf
    v_dot2_f32_bf16 v33, v107, v27, v33
    v_dot2_f32_bf16 v33, v108, v28, v33
    v_cvt_pk_bf16_f32 v32, 0, v32
    v_dot2_f32_bf16 v33, v109, v29, v33
    v_mul_f32 v32, s74, v32
    v_dot2_f32_bf16 v33, v110, v30, v33
    v_cvt_pk_bf16_f32 v32, 0, v32
    v_dot2_f32_bf16 v33, v111, v31, v33
    v_dot2_f32_bf16 v34, v112, v20, 0
    v_dot2_f32_bf16 v34, v113, v21, v34
    v_dot2_f32_bf16 v34, v114, v22, v34
    v_add_f32_dpp v33, v33, v33 quad_perm:[1,0,3,2] row_mask:0xf bank_mask:0xf
    v_dot2_f32_bf16 v34, v115, v23, v34
    s_add_u32 s70, s69, 19
    s_and_b32 s70, s70, 31
    s_mul_i32 s70, s70, 49152
    s_waitcnt vmcnt(4)
    buffer_load_dwordx4 a[216:219], v2, s[28:31], s70 offen offset:0 nt
    v_dot2_f32_bf16 v34, v116, v24, v34
    v_add_f32_dpp v33, v33, v33 quad_perm:[2,3,0,1] row_mask:0xf bank_mask:0xf
    v_dot2_f32_bf16 v34, v117, v25, v34
    v_dot2_f32_bf16 v34, v118, v26, v34
    v_add_f32_dpp v33, v33, v33 row_half_mirror row_mask:0xf bank_mask:0xf
    v_dot2_f32_bf16 v34, v119, v27, v34
    v_dot2_f32_bf16 v34, v120, v28, v34
    v_cvt_pk_bf16_f32 v33, 0, v33
    v_dot2_f32_bf16 v34, v121, v29, v34
    v_mul_f32 v33, s74, v33
    v_dot2_f32_bf16 v34, v122, v30, v34
    v_cvt_pk_bf16_f32 v33, 0, v33
    v_dot2_f32_bf16 v34, v123, v31, v34
    v_dot2_f32_bf16 v35, v124, v20, 0
    v_dot2_f32_bf16 v35, v125, v21, v35
    v_dot2_f32_bf16 v35, v126, v22, v35
    v_add_f32_dpp v34, v34, v34 quad_perm:[1,0,3,2] row_mask:0xf bank_mask:0xf
    v_dot2_f32_bf16 v35, v127, v23, v35
    v_dot2_f32_bf16 v35, v128, v24, v35
    v_add_f32_dpp v34, v34, v34 quad_perm:[2,3,0,1] row_mask:0xf bank_mask:0xf
    v_dot2_f32_bf16 v35, v129, v25, v35
    v_dot2_f32_bf16 v35, v130, v26, v35
    v_add_f32_dpp v34, v34, v34 row_half_mirror row_mask:0xf bank_mask:0xf
    v_dot2_f32_bf16 v35, v131, v27, v35
    v_dot2_f32_bf16 v35, v132, v28, v35
    v_cvt_pk_bf16_f32 v34, 0, v34
    v_dot2_f32_bf16 v35, v133, v29, v35
    v_mul_f32 v34, s74, v34
    v_dot2_f32_bf16 v35, v134, v30, v35
    v_cvt_pk_bf16_f32 v34, 0, v34
    v_dot2_f32_bf16 v35, v135, v31, v35
    v_dot2_f32_bf16 v36, v136, v20, 0
    v_dot2_f32_bf16 v36, v137, v21, v36
    v_dot2_f32_bf16 v36, v138, v22, v36
    v_add_f32_dpp v35, v35, v35 quad_perm:[1,0,3,2] row_mask:0xf bank_mask:0xf
    v_dot2_f32_bf16 v36, v139, v23, v36
    v_dot2_f32_bf16 v36, v140, v24, v36
    v_add_f32_dpp v35, v35, v35 quad_perm:[2,3,0,1] row_mask:0xf bank_mask:0xf
    v_dot2_f32_bf16 v36, v141, v25, v36
    v_dot2_f32_bf16 v36, v142, v26, v36
    v_add_f32_dpp v35, v35, v35 row_half_mirror row_mask:0xf bank_mask:0xf
    v_dot2_f32_bf16 v36, v143, v27, v36
    s_waitcnt vmcnt(4)
    buffer_load_dwordx4 a[220:223], v2, s[28:31], s70 offen offset:128 nt
    v_dot2_f32_bf16 v36, v144, v28, v36
    v_cvt_pk_bf16_f32 v35, 0, v35
    v_dot2_f32_bf16 v36, v145, v29, v36
    v_mul_f32 v35, s74, v35
    v_dot2_f32_bf16 v36, v146, v30, v36
    v_cvt_pk_bf16_f32 v35, 0, v35
    v_dot2_f32_bf16 v36, v147, v31, v36
    v_dot2_f32_bf16 v37, v148, v20, 0
    v_dot2_f32_bf16 v37, v149, v21, v37
    v_dot2_f32_bf16 v37, v150, v22, v37
    v_add_f32_dpp v36, v36, v36 quad_perm:[1,0,3,2] row_mask:0xf bank_mask:0xf
    v_dot2_f32_bf16 v37, v151, v23, v37
    v_dot2_f32_bf16 v37, v152, v24, v37
    v_add_f32_dpp v36, v36, v36 quad_perm:[2,3,0,1] row_mask:0xf bank_mask:0xf
    v_dot2_f32_bf16 v37, v153, v25, v37
    v_dot2_f32_bf16 v37, v154, v26, v37
    v_add_f32_dpp v36, v36, v36 row_half_mirror row_mask:0xf bank_mask:0xf
    v_dot2_f32_bf16 v37, v155, v27, v37
    v_dot2_f32_bf16 v37, v156, v28, v37
    v_cvt_pk_bf16_f32 v36, 0, v36
    v_dot2_f32_bf16 v37, v157, v29, v37
    v_mul_f32 v36, s74, v36
    v_dot2_f32_bf16 v37, v158, v30, v37
    v_cvt_pk_bf16_f32 v36, 0, v36
    v_dot2_f32_bf16 v37, v159, v31, v37
    v_dot2_f32_bf16 v38, v160, v20, 0
    v_dot2_f32_bf16 v38, v161, v21, v38
    v_dot2_f32_bf16 v38, v162, v22, v38
    v_add_f32_dpp v37, v37, v37 quad_perm:[1,0,3,2] row_mask:0xf bank_mask:0xf
    v_dot2_f32_bf16 v38, v163, v23, v38
    v_dot2_f32_bf16 v38, v164, v24, v38
    v_add_f32_dpp v37, v37, v37 quad_perm:[2,3,0,1] row_mask:0xf bank_mask:0xf
    v_dot2_f32_bf16 v38, v165, v25, v38
    v_dot2_f32_bf16 v38, v166, v26, v38
    v_add_f32_dpp v37, v37, v37 row_half_mirror row_mask:0xf bank_mask:0xf
    v_dot2_f32_bf16 v38, v167, v27, v38
    v_dot2_f32_bf16 v38, v168, v28, v38
    v_cvt_pk_bf16_f32 v37, 0, v37
    v_dot2_f32_bf16 v38, v169, v29, v38
    v_mul_f32 v37, s74, v37
    v_dot2_f32_bf16 v38, v170, v30, v38
    v_cvt_pk_bf16_f32 v37, 0, v37
    v_dot2_f32_bf16 v38, v171, v31, v38
    s_waitcnt vmcnt(4)
    buffer_load_dwordx4 a[224:227], v2, s[28:31], s70 offen offset:256 nt
    v_add_u32 v87, 17408, v87
    v_mov_b32 v86, 1
    buffer_atomic_add v86, v87, s[44:47], 0 offen sc0 sc1
    v_dot2_f32_bf16 v39, v172, v20, 0
    v_dot2_f32_bf16 v39, v173, v21, v39
    v_dot2_f32_bf16 v39, v174, v22, v39
    v_add_f32_dpp v38, v38, v38 quad_perm:[1,0,3,2] row_mask:0xf bank_mask:0xf
    v_dot2_f32_bf16 v39, v175, v23, v39
    v_dot2_f32_bf16 v39, v176, v24, v39
    v_add_f32_dpp v38, v38, v38 quad_perm:[2,3,0,1] row_mask:0xf bank_mask:0xf
    v_dot2_f32_bf16 v39, v177, v25, v39
    v_dot2_f32_bf16 v39, v178, v26, v39
    v_add_f32_dpp v38, v38, v38 row_half_mirror row_mask:0xf bank_mask:0xf
    v_dot2_f32_bf16 v39, v179, v27, v39
    v_dot2_f32_bf16 v39, v180, v28, v39
    v_cvt_pk_bf16_f32 v38, 0, v38
    v_dot2_f32_bf16 v39, v181, v29, v39
    v_mul_f32 v38, s74, v38
    v_dot2_f32_bf16 v39, v182, v30, v39
    v_cvt_pk_bf16_f32 v38, 0, v38
    v_dot2_f32_bf16 v39, v183, v31, v39
    v_dot2_f32_bf16 v40, v184, v20, 0
    v_dot2_f32_bf16 v40, v185, v21, v40
    v_dot2_f32_bf16 v40, v186, v22, v40
    v_add_f32_dpp v39, v39, v39 quad_perm:[1,0,3,2] row_mask:0xf bank_mask:0xf
    v_dot2_f32_bf16 v40, v187, v23, v40
    v_dot2_f32_bf16 v40, v188, v24, v40
    v_add_f32_dpp v39, v39, v39 quad_perm:[2,3,0,1] row_mask:0xf bank_mask:0xf
    v_dot2_f32_bf16 v40, v189, v25, v40
    v_dot2_f32_bf16 v40, v190, v26, v40
    v_add_f32_dpp v39, v39, v39 row_half_mirror row_mask:0xf bank_mask:0xf
    v_dot2_f32_bf16 v40, v191, v27, v40
    v_dot2_f32_bf16 v40, v192, v28, v40
    v_cvt_pk_bf16_f32 v39, 0, v39
    v_dot2_f32_bf16 v40, v193, v29, v40
    v_mul_f32 v39, s74, v39
    v_dot2_f32_bf16 v40, v194, v30, v40
    v_cvt_pk_bf16_f32 v39, 0, v39
    v_dot2_f32_bf16 v40, v195, v31, v40
    v_dot2_f32_bf16 v41, v196, v20, 0
    v_dot2_f32_bf16 v41, v197, v21, v41
    v_dot2_f32_bf16 v41, v198, v22, v41
    v_add_f32_dpp v40, v40, v40 quad_perm:[1,0,3,2] row_mask:0xf bank_mask:0xf
    v_dot2_f32_bf16 v41, v199, v23, v41
    s_add_u32 s70, s69, 20
    s_and_b32 s70, s70, 31
    s_mul_i32 s70, s70, 49152
    s_waitcnt vmcnt(5)
    buffer_load_dwordx4 a[228:231], v2, s[28:31], s70 offen offset:0 nt
    v_dot2_f32_bf16 v41, v200, v24, v41
    v_add_f32_dpp v40, v40, v40 quad_perm:[2,3,0,1] row_mask:0xf bank_mask:0xf
    v_dot2_f32_bf16 v41, v201, v25, v41
    v_dot2_f32_bf16 v41, v202, v26, v41
    v_add_f32_dpp v40, v40, v40 row_half_mirror row_mask:0xf bank_mask:0xf
    v_dot2_f32_bf16 v41, v203, v27, v41
    v_dot2_f32_bf16 v41, v204, v28, v41
    v_cvt_pk_bf16_f32 v40, 0, v40
    v_dot2_f32_bf16 v41, v205, v29, v41
    v_mul_f32 v40, s74, v40
    v_dot2_f32_bf16 v41, v206, v30, v41
    v_cvt_pk_bf16_f32 v40, 0, v40
    v_dot2_f32_bf16 v41, v207, v31, v41
    v_dot2_f32_bf16 v42, v208, v20, 0
    v_dot2_f32_bf16 v42, v209, v21, v42
    v_dot2_f32_bf16 v42, v210, v22, v42
    v_add_f32_dpp v41, v41, v41 quad_perm:[1,0,3,2] row_mask:0xf bank_mask:0xf
    v_dot2_f32_bf16 v42, v211, v23, v42
    v_dot2_f32_bf16 v42, v212, v24, v42
    v_add_f32_dpp v41, v41, v41 quad_perm:[2,3,0,1] row_mask:0xf bank_mask:0xf
    v_dot2_f32_bf16 v42, v213, v25, v42
    v_dot2_f32_bf16 v42, v214, v26, v42
    v_add_f32_dpp v41, v41, v41 row_half_mirror row_mask:0xf bank_mask:0xf
    v_dot2_f32_bf16 v42, v215, v27, v42
    v_dot2_f32_bf16 v42, v216, v28, v42
    v_cvt_pk_bf16_f32 v41, 0, v41
    v_dot2_f32_bf16 v42, v217, v29, v42
    v_mul_f32 v41, s74, v41
    v_dot2_f32_bf16 v42, v218, v30, v42
    v_cvt_pk_bf16_f32 v41, 0, v41
    v_dot2_f32_bf16 v42, v219, v31, v42
    v_dot2_f32_bf16 v43, v220, v20, 0
    v_dot2_f32_bf16 v43, v221, v21, v43
    v_dot2_f32_bf16 v43, v222, v22, v43
    v_add_f32_dpp v42, v42, v42 quad_perm:[1,0,3,2] row_mask:0xf bank_mask:0xf
    v_dot2_f32_bf16 v43, v223, v23, v43
    v_dot2_f32_bf16 v43, v224, v24, v43
    v_add_f32_dpp v42, v42, v42 quad_perm:[2,3,0,1] row_mask:0xf bank_mask:0xf
    v_dot2_f32_bf16 v43, v225, v25, v43
    v_dot2_f32_bf16 v43, v226, v26, v43
    v_add_f32_dpp v42, v42, v42 row_half_mirror row_mask:0xf bank_mask:0xf
    v_dot2_f32_bf16 v43, v227, v27, v43
    s_waitcnt vmcnt(5)
    buffer_load_dwordx4 a[232:235], v2, s[28:31], s70 offen offset:128 nt
    v_dot2_f32_bf16 v43, v228, v28, v43
    v_cvt_pk_bf16_f32 v42, 0, v42
    v_dot2_f32_bf16 v43, v229, v29, v43
    v_mul_f32 v42, s74, v42
    v_dot2_f32_bf16 v43, v230, v30, v43
    v_cvt_pk_bf16_f32 v42, 0, v42
    v_dot2_f32_bf16 v43, v231, v31, v43
    v_dot2_f32_bf16 v44, v232, v20, 0
    v_dot2_f32_bf16 v44, v233, v21, v44
    v_dot2_f32_bf16 v44, v234, v22, v44
    v_add_f32_dpp v43, v43, v43 quad_perm:[1,0,3,2] row_mask:0xf bank_mask:0xf
    v_dot2_f32_bf16 v44, v235, v23, v44
    v_dot2_f32_bf16 v44, v236, v24, v44
    v_add_f32_dpp v43, v43, v43 quad_perm:[2,3,0,1] row_mask:0xf bank_mask:0xf
    v_dot2_f32_bf16 v44, v237, v25, v44
    v_dot2_f32_bf16 v44, v238, v26, v44
    v_add_f32_dpp v43, v43, v43 row_half_mirror row_mask:0xf bank_mask:0xf
    v_dot2_f32_bf16 v44, v239, v27, v44
    v_dot2_f32_bf16 v44, v240, v28, v44
    v_cvt_pk_bf16_f32 v43, 0, v43
    v_dot2_f32_bf16 v44, v241, v29, v44
    v_mul_f32 v43, s74, v43
    v_dot2_f32_bf16 v44, v242, v30, v44
    v_cvt_pk_bf16_f32 v43, 0, v43
    v_dot2_f32_bf16 v44, v243, v31, v44
    v_dot2_f32_bf16 v45, v244, v20, 0
    v_dot2_f32_bf16 v45, v245, v21, v45
    v_dot2_f32_bf16 v45, v246, v22, v45
    v_add_f32_dpp v44, v44, v44 quad_perm:[1,0,3,2] row_mask:0xf bank_mask:0xf
    v_dot2_f32_bf16 v45, v247, v23, v45
    v_dot2_f32_bf16 v45, v248, v24, v45
    v_add_f32_dpp v44, v44, v44 quad_perm:[2,3,0,1] row_mask:0xf bank_mask:0xf
    v_dot2_f32_bf16 v45, v249, v25, v45
    v_dot2_f32_bf16 v45, v250, v26, v45
    v_add_f32_dpp v44, v44, v44 row_half_mirror row_mask:0xf bank_mask:0xf
    v_dot2_f32_bf16 v45, v251, v27, v45
    v_dot2_f32_bf16 v45, v252, v28, v45
    v_cvt_pk_bf16_f32 v44, 0, v44
    v_dot2_f32_bf16 v45, v253, v29, v45
    v_mul_f32 v44, s74, v44
    v_dot2_f32_bf16 v45, v254, v30, v45
    v_cvt_pk_bf16_f32 v44, 0, v44
    v_dot2_f32_bf16 v45, v255, v31, v45
    s_waitcnt vmcnt(5)
    buffer_load_dwordx4 a[236:239], v2, s[28:31], s70 offen offset:256 nt
    v_accvgpr_read_b32 v64, a156
    v_accvgpr_read_b32 v65, a157
    v_accvgpr_read_b32 v66, a158
    v_accvgpr_read_b32 v67, a159
    v_dot2_f32_bf16 v46, v64, v20, 0
    v_dot2_f32_bf16 v46, v65, v21, v46
    v_dot2_f32_bf16 v46, v66, v22, v46
    v_add_f32_dpp v45, v45, v45 quad_perm:[1,0,3,2] row_mask:0xf bank_mask:0xf
    v_dot2_f32_bf16 v46, v67, v23, v46
    v_accvgpr_read_b32 v64, a160
    v_accvgpr_read_b32 v65, a161
    v_accvgpr_read_b32 v66, a162
    v_accvgpr_read_b32 v67, a163
    v_dot2_f32_bf16 v46, v64, v24, v46
    v_add_f32_dpp v45, v45, v45 quad_perm:[2,3,0,1] row_mask:0xf bank_mask:0xf
    v_dot2_f32_bf16 v46, v65, v25, v46
    v_dot2_f32_bf16 v46, v66, v26, v46
    v_add_f32_dpp v45, v45, v45 row_half_mirror row_mask:0xf bank_mask:0xf
    v_dot2_f32_bf16 v46, v67, v27, v46
    v_accvgpr_read_b32 v64, a164
    v_accvgpr_read_b32 v65, a165
    v_accvgpr_read_b32 v66, a166
    v_accvgpr_read_b32 v67, a167
    v_dot2_f32_bf16 v46, v64, v28, v46
    v_cvt_pk_bf16_f32 v45, 0, v45
    v_dot2_f32_bf16 v46, v65, v29, v46
    v_mul_f32 v45, s74, v45
    v_dot2_f32_bf16 v46, v66, v30, v46
    v_cvt_pk_bf16_f32 v45, 0, v45
    v_dot2_f32_bf16 v46, v67, v31, v46
    v_accvgpr_read_b32 v64, a168
    v_accvgpr_read_b32 v65, a169
    v_accvgpr_read_b32 v66, a170
    v_accvgpr_read_b32 v67, a171
    v_dot2_f32_bf16 v47, v64, v20, 0
    v_dot2_f32_bf16 v47, v65, v21, v47
    v_dot2_f32_bf16 v47, v66, v22, v47
    v_add_f32_dpp v46, v46, v46 quad_perm:[1,0,3,2] row_mask:0xf bank_mask:0xf
    v_dot2_f32_bf16 v47, v67, v23, v47
    v_accvgpr_read_b32 v64, a172
    v_accvgpr_read_b32 v65, a173
    v_accvgpr_read_b32 v66, a174
    v_accvgpr_read_b32 v67, a175
    v_dot2_f32_bf16 v47, v64, v24, v47
    v_add_f32_dpp v46, v46, v46 quad_perm:[2,3,0,1] row_mask:0xf bank_mask:0xf
    v_dot2_f32_bf16 v47, v65, v25, v47
    v_dot2_f32_bf16 v47, v66, v26, v47
    v_add_f32_dpp v46, v46, v46 row_half_mirror row_mask:0xf bank_mask:0xf
    v_dot2_f32_bf16 v47, v67, v27, v47
    s_add_u32 s70, s69, 21
    s_and_b32 s70, s70, 31
    s_mul_i32 s70, s70, 49152
    s_waitcnt vmcnt(5)
    buffer_load_dwordx4 a[240:243], v2, s[28:31], s70 offen offset:0 nt
    v_accvgpr_read_b32 v64, a176
    v_accvgpr_read_b32 v65, a177
    v_accvgpr_read_b32 v66, a178
    v_accvgpr_read_b32 v67, a179
    v_dot2_f32_bf16 v47, v64, v28, v47
    v_cvt_pk_bf16_f32 v46, 0, v46
    v_dot2_f32_bf16 v47, v65, v29, v47
    v_mul_f32 v46, s74, v46
    v_dot2_f32_bf16 v47, v66, v30, v47
    v_cvt_pk_bf16_f32 v46, 0, v46
    v_dot2_f32_bf16 v47, v67, v31, v47
    v_accvgpr_read_b32 v64, a180
    v_accvgpr_read_b32 v65, a181
    v_accvgpr_read_b32 v66, a182
    v_accvgpr_read_b32 v67, a183
    v_dot2_f32_bf16 v48, v64, v20, 0
    v_dot2_f32_bf16 v48, v65, v21, v48
    v_dot2_f32_bf16 v48, v66, v22, v48
    v_add_f32_dpp v47, v47, v47 quad_perm:[1,0,3,2] row_mask:0xf bank_mask:0xf
    v_dot2_f32_bf16 v48, v67, v23, v48
    v_accvgpr_read_b32 v64, a184
    v_accvgpr_read_b32 v65, a185
    v_accvgpr_read_b32 v66, a186
    v_accvgpr_read_b32 v67, a187
    v_dot2_f32_bf16 v48, v64, v24, v48
    v_add_f32_dpp v47, v47, v47 quad_perm:[2,3,0,1] row_mask:0xf bank_mask:0xf
    v_dot2_f32_bf16 v48, v65, v25, v48
    v_dot2_f32_bf16 v48, v66, v26, v48
    v_add_f32_dpp v47, v47, v47 row_half_mirror row_mask:0xf bank_mask:0xf
    v_dot2_f32_bf16 v48, v67, v27, v48
    v_accvgpr_read_b32 v64, a188
    v_accvgpr_read_b32 v65, a189
    v_accvgpr_read_b32 v66, a190
    v_accvgpr_read_b32 v67, a191
    v_dot2_f32_bf16 v48, v64, v28, v48
    v_cvt_pk_bf16_f32 v47, 0, v47
    v_dot2_f32_bf16 v48, v65, v29, v48
    v_mul_f32 v47, s74, v47
    v_dot2_f32_bf16 v48, v66, v30, v48
    v_cvt_pk_bf16_f32 v47, 0, v47
    v_dot2_f32_bf16 v48, v67, v31, v48
    v_accvgpr_read_b32 v64, a192
    v_accvgpr_read_b32 v65, a193
    v_accvgpr_read_b32 v66, a194
    v_accvgpr_read_b32 v67, a195
    v_dot2_f32_bf16 v49, v64, v20, 0
    v_dot2_f32_bf16 v49, v65, v21, v49
    v_dot2_f32_bf16 v49, v66, v22, v49
    v_add_f32_dpp v48, v48, v48 quad_perm:[1,0,3,2] row_mask:0xf bank_mask:0xf
    v_dot2_f32_bf16 v49, v67, v23, v49
    s_waitcnt vmcnt(5)
    buffer_load_dwordx4 a[244:247], v2, s[28:31], s70 offen offset:128 nt
    v_accvgpr_read_b32 v64, a196
    v_accvgpr_read_b32 v65, a197
    v_accvgpr_read_b32 v66, a198
    v_accvgpr_read_b32 v67, a199
    v_dot2_f32_bf16 v49, v64, v24, v49
    v_add_f32_dpp v48, v48, v48 quad_perm:[2,3,0,1] row_mask:0xf bank_mask:0xf
    v_dot2_f32_bf16 v49, v65, v25, v49
    v_dot2_f32_bf16 v49, v66, v26, v49
    v_add_f32_dpp v48, v48, v48 row_half_mirror row_mask:0xf bank_mask:0xf
    v_dot2_f32_bf16 v49, v67, v27, v49
    v_accvgpr_read_b32 v64, a200
    v_accvgpr_read_b32 v65, a201
    v_accvgpr_read_b32 v66, a202
    v_accvgpr_read_b32 v67, a203
    v_dot2_f32_bf16 v49, v64, v28, v49
    v_cvt_pk_bf16_f32 v48, 0, v48
    v_dot2_f32_bf16 v49, v65, v29, v49
    v_mul_f32 v48, s74, v48
    v_dot2_f32_bf16 v49, v66, v30, v49
    v_cvt_pk_bf16_f32 v48, 0, v48
    v_dot2_f32_bf16 v49, v67, v31, v49
    v_accvgpr_read_b32 v64, a204
    v_accvgpr_read_b32 v65, a205
    v_accvgpr_read_b32 v66, a206
    v_accvgpr_read_b32 v67, a207
    v_dot2_f32_bf16 v50, v64, v20, 0
    v_dot2_f32_bf16 v50, v65, v21, v50
    v_dot2_f32_bf16 v50, v66, v22, v50
    v_add_f32_dpp v49, v49, v49 quad_perm:[1,0,3,2] row_mask:0xf bank_mask:0xf
    v_dot2_f32_bf16 v50, v67, v23, v50
    v_accvgpr_read_b32 v64, a208
    v_accvgpr_read_b32 v65, a209
    v_accvgpr_read_b32 v66, a210
    v_accvgpr_read_b32 v67, a211
    v_dot2_f32_bf16 v50, v64, v24, v50
    v_add_f32_dpp v49, v49, v49 quad_perm:[2,3,0,1] row_mask:0xf bank_mask:0xf
    v_dot2_f32_bf16 v50, v65, v25, v50
    v_dot2_f32_bf16 v50, v66, v26, v50
    v_add_f32_dpp v49, v49, v49 row_half_mirror row_mask:0xf bank_mask:0xf
    v_dot2_f32_bf16 v50, v67, v27, v50
    v_accvgpr_read_b32 v64, a212
    v_accvgpr_read_b32 v65, a213
    v_accvgpr_read_b32 v66, a214
    v_accvgpr_read_b32 v67, a215
    v_dot2_f32_bf16 v50, v64, v28, v50
    v_cvt_pk_bf16_f32 v49, 0, v49
    v_dot2_f32_bf16 v50, v65, v29, v50
    v_mul_f32 v49, s74, v49
    v_dot2_f32_bf16 v50, v66, v30, v50
    v_cvt_pk_bf16_f32 v49, 0, v49
    v_dot2_f32_bf16 v50, v67, v31, v50
    buffer_load_dwordx4 a[248:251], v2, s[28:31], s70 offen offset:256 nt
    v_accvgpr_read_b32 v64, a216
    v_accvgpr_read_b32 v65, a217
    v_accvgpr_read_b32 v66, a218
    v_accvgpr_read_b32 v67, a219
    v_dot2_f32_bf16 v51, v64, v20, 0
    v_dot2_f32_bf16 v51, v65, v21, v51
    v_dot2_f32_bf16 v51, v66, v22, v51
    v_add_f32_dpp v50, v50, v50 quad_perm:[1,0,3,2] row_mask:0xf bank_mask:0xf
    v_dot2_f32_bf16 v51, v67, v23, v51
    v_accvgpr_read_b32 v64, a220
    v_accvgpr_read_b32 v65, a221
    v_accvgpr_read_b32 v66, a222
    v_accvgpr_read_b32 v67, a223
    v_dot2_f32_bf16 v51, v64, v24, v51
    v_add_f32_dpp v50, v50, v50 quad_perm:[2,3,0,1] row_mask:0xf bank_mask:0xf
    v_dot2_f32_bf16 v51, v65, v25, v51
    v_dot2_f32_bf16 v51, v66, v26, v51
    v_add_f32_dpp v50, v50, v50 row_half_mirror row_mask:0xf bank_mask:0xf
    v_dot2_f32_bf16 v51, v67, v27, v51
    v_accvgpr_read_b32 v64, a224
    v_accvgpr_read_b32 v65, a225
    v_accvgpr_read_b32 v66, a226
    v_accvgpr_read_b32 v67, a227
    v_dot2_f32_bf16 v51, v64, v28, v51
    v_cvt_pk_bf16_f32 v50, 0, v50
    v_dot2_f32_bf16 v51, v65, v29, v51
    v_mul_f32 v50, s74, v50
    v_dot2_f32_bf16 v51, v66, v30, v51
    v_cvt_pk_bf16_f32 v50, 0, v50
    v_dot2_f32_bf16 v51, v67, v31, v51
    s_add_u32 s70, s69, 22
    s_and_b32 s70, s70, 31
    s_mul_i32 s70, s70, 49152
    buffer_load_dwordx4 v[88:91], v2, s[28:31], s70 offen offset:0 nt
    s_waitcnt vmcnt(4)
    buffer_load_dwordx4 v[92:95], v2, s[28:31], s70 offen offset:128 nt
    s_mov_b64 exec, 1
    ds_write_b32 v17, v86 offset:16944
    s_mov_b64 exec, -1
    v_accvgpr_read_b32 v64, a228
    v_accvgpr_read_b32 v65, a229
    v_accvgpr_read_b32 v66, a230
    v_accvgpr_read_b32 v67, a231
    v_dot2_f32_bf16 v52, v64, v20, 0
    v_dot2_f32_bf16 v52, v65, v21, v52
    v_dot2_f32_bf16 v52, v66, v22, v52
    v_add_f32_dpp v51, v51, v51 quad_perm:[1,0,3,2] row_mask:0xf bank_mask:0xf
    v_dot2_f32_bf16 v52, v67, v23, v52
    v_accvgpr_read_b32 v64, a232
    v_accvgpr_read_b32 v65, a233
    v_accvgpr_read_b32 v66, a234
    v_accvgpr_read_b32 v67, a235
    v_dot2_f32_bf16 v52, v64, v24, v52
    v_add_f32_dpp v51, v51, v51 quad_perm:[2,3,0,1] row_mask:0xf bank_mask:0xf
    v_dot2_f32_bf16 v52, v65, v25, v52
    v_dot2_f32_bf16 v52, v66, v26, v52
    v_add_f32_dpp v51, v51, v51 row_half_mirror row_mask:0xf bank_mask:0xf
    v_dot2_f32_bf16 v52, v67, v27, v52
    v_accvgpr_read_b32 v64, a236
    v_accvgpr_read_b32 v65, a237
    v_accvgpr_read_b32 v66, a238
    v_accvgpr_read_b32 v67, a239
    v_dot2_f32_bf16 v52, v64, v28, v52
    v_cvt_pk_bf16_f32 v51, 0, v51
    v_dot2_f32_bf16 v52, v65, v29, v52
    v_mul_f32 v51, s74, v51
    v_dot2_f32_bf16 v52, v66, v30, v52
    v_cvt_pk_bf16_f32 v51, 0, v51
    v_dot2_f32_bf16 v52, v67, v31, v52
    s_waitcnt vmcnt(4)
    buffer_load_dwordx4 v[96:99], v2, s[28:31], s70 offen offset:256 nt
    v_accvgpr_read_b32 v64, a240
    v_accvgpr_read_b32 v65, a241
    v_accvgpr_read_b32 v66, a242
    v_accvgpr_read_b32 v67, a243
    v_dot2_f32_bf16 v53, v64, v20, 0
    v_dot2_f32_bf16 v53, v65, v21, v53
    v_dot2_f32_bf16 v53, v66, v22, v53
    v_add_f32_dpp v52, v52, v52 quad_perm:[1,0,3,2] row_mask:0xf bank_mask:0xf
    v_dot2_f32_bf16 v53, v67, v23, v53
    s_add_u32 s70, s69, 23
    s_and_b32 s70, s70, 31
    s_mul_i32 s70, s70, 49152
    s_waitcnt vmcnt(4)
    buffer_load_dwordx4 v[100:103], v2, s[28:31], s70 offen offset:0 nt
    v_accvgpr_read_b32 v64, a244
    v_accvgpr_read_b32 v65, a245
    v_accvgpr_read_b32 v66, a246
    v_accvgpr_read_b32 v67, a247
    v_dot2_f32_bf16 v53, v64, v24, v53
    v_add_f32_dpp v52, v52, v52 quad_perm:[2,3,0,1] row_mask:0xf bank_mask:0xf
    v_dot2_f32_bf16 v53, v65, v25, v53
    v_dot2_f32_bf16 v53, v66, v26, v53
    v_add_f32_dpp v52, v52, v52 row_half_mirror row_mask:0xf bank_mask:0xf
    v_dot2_f32_bf16 v53, v67, v27, v53
    s_waitcnt vmcnt(4)
    buffer_load_dwordx4 v[104:107], v2, s[28:31], s70 offen offset:128 nt
    ds_read_b32 v86, v14 offset:16944
    v_accvgpr_read_b32 v64, a248
    v_accvgpr_read_b32 v65, a249
    v_accvgpr_read_b32 v66, a250
    v_accvgpr_read_b32 v67, a251
    v_dot2_f32_bf16 v53, v64, v28, v53
    v_cvt_pk_bf16_f32 v52, 0, v52
    v_dot2_f32_bf16 v53, v65, v29, v53
    v_mul_f32 v52, s74, v52
    v_dot2_f32_bf16 v53, v66, v30, v53
    v_cvt_pk_bf16_f32 v52, 0, v52
    v_dot2_f32_bf16 v53, v67, v31, v53
    s_waitcnt vmcnt(4)
    buffer_load_dwordx4 v[108:111], v2, s[28:31], s70 offen offset:256 nt
    s_waitcnt lgkmcnt(0)
    v_readfirstlane_b32 s57, v86
    s_mov_b32 s56, 0
    s_cmp_ge_i32 s57, 31
    s_addc_u32 s56, s56, 0
    s_cmp_ge_i32 s57, 51
    s_addc_u32 s56, s56, 0
    v_dot2_f32_bf16 v54, v88, v20, 0
    v_dot2_f32_bf16 v54, v89, v21, v54
    v_dot2_f32_bf16 v54, v90, v22, v54
    v_add_f32_dpp v53, v53, v53 quad_perm:[1,0,3,2] row_mask:0xf bank_mask:0xf
    v_dot2_f32_bf16 v54, v91, v23, v54
    s_add_u32 s70, s69, 24
    s_and_b32 s70, s70, 31
    s_mul_i32 s70, s70, 49152
    s_cmp_ge_u32 s56, 1
    s_cbranch_scc1 L_w1
    s_waitcnt vmcnt(4)
L_w1:
    buffer_load_dwordx4 v[112:115], v2, s[28:31], s70 offen offset:0 nt
    s_cmp_ge_u32 s56, 2
    s_cbranch_scc1 L_w2
    s_waitcnt vmcnt(5)
    s_cmp_ge_u32 s56, 1
    s_cbranch_scc1 L_w2
    s_waitcnt vmcnt(4)
L_w2:
    buffer_load_dwordx4 v[116:119], v2, s[28:31], s70 offen offset:128 nt
    s_cmp_ge_u32 s56, 2
    s_cbranch_scc1 L_w3
    s_waitcnt vmcnt(5)
    s_cmp_ge_u32 s56, 1
    s_cbranch_scc1 L_w3
    s_waitcnt vmcnt(4)
L_w3:
    buffer_load_dwordx4 v[120:123], v2, s[28:31], s70 offen offset:256 nt
    s_add_u32 s70, s69, 25
    s_and_b32 s70, s70, 31
    s_mul_i32 s70, s70, 49152
    s_waitcnt vmcnt(7)
    s_cmp_ge_u32 s56, 2
    s_cbranch_scc1 L_w4
    s_waitcnt vmcnt(5)
    s_cmp_ge_u32 s56, 1
    s_cbranch_scc1 L_w4
    s_waitcnt vmcnt(4)
L_w4:
    buffer_load_dwordx4 v[124:127], v2, s[28:31], s70 offen offset:0 nt
    ds_read_b32 v86, v14 offset:16944
    v_dot2_f32_bf16 v54, v92, v24, v54
    v_add_f32_dpp v53, v53, v53 quad_perm:[2,3,0,1] row_mask:0xf bank_mask:0xf
    v_dot2_f32_bf16 v54, v93, v25, v54
    v_dot2_f32_bf16 v54, v94, v26, v54
    v_add_f32_dpp v53, v53, v53 row_half_mirror row_mask:0xf bank_mask:0xf
    v_dot2_f32_bf16 v54, v95, v27, v54
    s_waitcnt vmcnt(7)
    s_cmp_ge_u32 s56, 2
    s_cbranch_scc1 L_w5
    s_waitcnt vmcnt(5)
    s_cmp_ge_u32 s56, 1
    s_cbranch_scc1 L_w5
    s_waitcnt vmcnt(4)
L_w5:
    buffer_load_dwordx4 v[128:131], v2, s[28:31], s70 offen offset:128 nt
    s_waitcnt lgkmcnt(0)
    v_readfirstlane_b32 s57, v86
    s_mov_b32 s56, 0
    s_cmp_ge_i32 s57, 31
    s_addc_u32 s56, s56, 0
    s_cmp_ge_i32 s57, 51
    s_addc_u32 s56, s56, 0
    v_dot2_f32_bf16 v54, v96, v28, v54
    v_cvt_pk_bf16_f32 v53, 0, v53
    v_dot2_f32_bf16 v54, v97, v29, v54
    v_mul_f32 v53, s74, v53
    v_dot2_f32_bf16 v54, v98, v30, v54
    v_cvt_pk_bf16_f32 v53, 0, v53
    v_dot2_f32_bf16 v54, v99, v31, v54
    s_waitcnt vmcnt(7)
    s_cmp_ge_u32 s56, 2
    s_cbranch_scc1 L_w6
    s_waitcnt vmcnt(5)
    s_cmp_ge_u32 s56, 1
    s_cbranch_scc1 L_w6
    s_waitcnt vmcnt(4)
L_w6:
    buffer_load_dwordx4 v[132:135], v2, s[28:31], s70 offen offset:256 nt
    v_dot2_f32_bf16 v55, v100, v20, 0
    v_dot2_f32_bf16 v55, v101, v21, v55
    v_dot2_f32_bf16 v55, v102, v22, v55
    v_add_f32_dpp v54, v54, v54 quad_perm:[1,0,3,2] row_mask:0xf bank_mask:0xf
    v_dot2_f32_bf16 v55, v103, v23, v55
    s_add_u32 s70, s69, 26
    s_and_b32 s70, s70, 31
    s_mul_i32 s70, s70, 49152
    s_waitcnt vmcnt(7)
    s_cmp_ge_u32 s56, 2
    s_cbranch_scc1 L_w7
    s_waitcnt vmcnt(5)
    s_cmp_ge_u32 s56, 1
    s_cbranch_scc1 L_w7
    s_waitcnt vmcnt(4)
L_w7:
    buffer_load_dwordx4 v[136:139], v2, s[28:31], s70 offen offset:0 nt
    v_dot2_f32_bf16 v55, v104, v24, v55
    v_add_f32_dpp v54, v54, v54 quad_perm:[2,3,0,1] row_mask:0xf bank_mask:0xf
    v_dot2_f32_bf16 v55, v105, v25, v55
    v_dot2_f32_bf16 v55, v106, v26, v55
    v_add_f32_dpp v54, v54, v54 row_half_mirror row_mask:0xf bank_mask:0xf
    v_dot2_f32_bf16 v55, v107, v27, v55
    s_waitcnt vmcnt(7)
    s_cmp_ge_u32 s56, 2
    s_cbranch_scc1 L_w8
    s_waitcnt vmcnt(5)
    s_cmp_ge_u32 s56, 1
    s_cbranch_scc1 L_w8
    s_waitcnt vmcnt(4)
L_w8:
    buffer_load_dwordx4 v[140:143], v2, s[28:31], s70 offen offset:128 nt
    v_dot2_f32_bf16 v55, v108, v28, v55
    v_cvt_pk_bf16_f32 v54, 0, v54
    v_dot2_f32_bf16 v55, v109, v29, v55
    v_mul_f32 v54, s74, v54
    v_dot2_f32_bf16 v55, v110, v30, v55
    v_cvt_pk_bf16_f32 v54, 0, v54
    v_dot2_f32_bf16 v55, v111, v31, v55
    s_waitcnt vmcnt(7)
    s_cmp_ge_u32 s56, 2
    s_cbranch_scc1 L_w9
    s_waitcnt vmcnt(5)
    s_cmp_ge_u32 s56, 1
    s_cbranch_scc1 L_w9
    s_waitcnt vmcnt(4)
L_w9:
    buffer_load_dwordx4 v[144:147], v2, s[28:31], s70 offen offset:256 nt
    v_dot2_f32_bf16 v56, v112, v20, 0
    v_dot2_f32_bf16 v56, v113, v21, v56
    v_dot2_f32_bf16 v56, v114, v22, v56
    v_add_f32_dpp v55, v55, v55 quad_perm:[1,0,3,2] row_mask:0xf bank_mask:0xf
    v_dot2_f32_bf16 v56, v115, v23, v56
    s_add_u32 s70, s69, 27
    s_and_b32 s70, s70, 31
    s_mul_i32 s70, s70, 49152
    s_waitcnt vmcnt(7)
    s_cmp_ge_u32 s56, 2
    s_cbranch_scc1 L_w10
    s_waitcnt vmcnt(5)
    s_cmp_ge_u32 s56, 1
    s_cbranch_scc1 L_w10
    s_waitcnt vmcnt(4)
L_w10:
    buffer_load_dwordx4 v[148:151], v2, s[28:31], s70 offen offset:0 nt
    v_dot2_f32_bf16 v56, v116, v24, v56
    v_add_f32_dpp v55, v55, v55 quad_perm:[2,3,0,1] row_mask:0xf bank_mask:0xf
    v_dot2_f32_bf16 v56, v117, v25, v56
    v_dot2_f32_bf16 v56, v118, v26, v56
    v_add_f32_dpp v55, v55, v55 row_half_mirror row_mask:0xf bank_mask:0xf
    v_dot2_f32_bf16 v56, v119, v27, v56
    s_waitcnt vmcnt(7)
    s_cmp_ge_u32 s56, 2
    s_cbranch_scc1 L_w11
    s_waitcnt vmcnt(5)
    s_cmp_ge_u32 s56, 1
    s_cbranch_scc1 L_w11
    s_waitcnt vmcnt(4)
L_w11:
    buffer_load_dwordx4 v[152:155], v2, s[28:31], s70 offen offset:128 nt
    v_dot2_f32_bf16 v56, v120, v28, v56
    v_cvt_pk_bf16_f32 v55, 0, v55
    v_dot2_f32_bf16 v56, v121, v29, v56
    v_mul_f32 v55, s74, v55
    v_dot2_f32_bf16 v56, v122, v30, v56
    v_cvt_pk_bf16_f32 v55, 0, v55
    v_dot2_f32_bf16 v56, v123, v31, v56
    s_waitcnt vmcnt(7)
    s_cmp_ge_u32 s56, 2
    s_cbranch_scc1 L_w12
    s_waitcnt vmcnt(5)
    s_cmp_ge_u32 s56, 1
    s_cbranch_scc1 L_w12
    s_waitcnt vmcnt(4)
L_w12:
    buffer_load_dwordx4 v[156:159], v2, s[28:31], s70 offen offset:256 nt
    v_dot2_f32_bf16 v57, v124, v20, 0
    v_dot2_f32_bf16 v57, v125, v21, v57
    v_dot2_f32_bf16 v57, v126, v22, v57
    v_add_f32_dpp v56, v56, v56 quad_perm:[1,0,3,2] row_mask:0xf bank_mask:0xf
    v_dot2_f32_bf16 v57, v127, v23, v57
    s_add_u32 s70, s69, 28
    s_and_b32 s70, s70, 31
    s_mul_i32 s70, s70, 49152
    s_waitcnt vmcnt(7)
    s_cmp_ge_u32 s56, 2
    s_cbranch_scc1 L_w13
    s_waitcnt vmcnt(5)
    s_cmp_ge_u32 s56, 1
    s_cbranch_scc1 L_w13
    s_waitcnt vmcnt(4)
L_w13:
    buffer_load_dwordx4 v[160:163], v2, s[28:31], s70 offen offset:0 nt
    v_dot2_f32_bf16 v57, v128, v24, v57
    v_add_f32_dpp v56, v56, v56 quad_perm:[2,3,0,1] row_mask:0xf bank_mask:0xf
    v_dot2_f32_bf16 v57, v129, v25, v57
    v_dot2_f32_bf16 v57, v130, v26, v57
    v_add_f32_dpp v56, v56, v56 row_half_mirror row_mask:0xf bank_mask:0xf
    v_dot2_f32_bf16 v57, v131, v27, v57
    s_waitcnt vmcnt(7)
    s_cmp_ge_u32 s56, 2
    s_cbranch_scc1 L_w14
    s_waitcnt vmcnt(5)
    s_cmp_ge_u32 s56, 1
    s_cbranch_scc1 L_w14
    s_waitcnt vmcnt(4)
L_w14:
    buffer_load_dwordx4 v[164:167], v2, s[28:31], s70 offen offset:128 nt
    v_dot2_f32_bf16 v57, v132, v28, v57
    v_cvt_pk_bf16_f32 v56, 0, v56
    v_dot2_f32_bf16 v57, v133, v29, v57
    v_mul_f32 v56, s74, v56
    v_dot2_f32_bf16 v57, v134, v30, v57
    v_cvt_pk_bf16_f32 v56, 0, v56
    v_dot2_f32_bf16 v57, v135, v31, v57
    s_waitcnt vmcnt(7)
    s_cmp_ge_u32 s56, 2
    s_cbranch_scc1 L_w15
    s_waitcnt vmcnt(5)
    s_cmp_ge_u32 s56, 1
    s_cbranch_scc1 L_w15
    s_waitcnt vmcnt(4)
L_w15:
    buffer_load_dwordx4 v[168:171], v2, s[28:31], s70 offen offset:256 nt
    v_dot2_f32_bf16 v58, v136, v20, 0
    v_dot2_f32_bf16 v58, v137, v21, v58
    v_dot2_f32_bf16 v58, v138, v22, v58
    v_add_f32_dpp v57, v57, v57 quad_perm:[1,0,3,2] row_mask:0xf bank_mask:0xf
    v_dot2_f32_bf16 v58, v139, v23, v58
    s_add_u32 s70, s69, 29
    s_and_b32 s70, s70, 31
    s_mul_i32 s70, s70, 49152
    s_waitcnt vmcnt(7)
    s_cmp_ge_u32 s56, 2
    s_cbranch_scc1 L_w16
    s_waitcnt vmcnt(5)
    s_cmp_ge_u32 s56, 1
    s_cbranch_scc1 L_w16
    s_waitcnt vmcnt(4)
L_w16:
    buffer_load_dwordx4 v[172:175], v2, s[28:31], s70 offen offset:0 nt
    v_dot2_f32_bf16 v58, v140, v24, v58
    v_add_f32_dpp v57, v57, v57 quad_perm:[2,3,0,1] row_mask:0xf bank_mask:0xf
    v_dot2_f32_bf16 v58, v141, v25, v58
    v_dot2_f32_bf16 v58, v142, v26, v58
    v_add_f32_dpp v57, v57, v57 row_half_mirror row_mask:0xf bank_mask:0xf
    v_dot2_f32_bf16 v58, v143, v27, v58
    s_waitcnt vmcnt(7)
    s_cmp_ge_u32 s56, 2
    s_cbranch_scc1 L_w17
    s_waitcnt vmcnt(5)
    s_cmp_ge_u32 s56, 1
    s_cbranch_scc1 L_w17
    s_waitcnt vmcnt(4)
L_w17:
    buffer_load_dwordx4 v[176:179], v2, s[28:31], s70 offen offset:128 nt
    v_dot2_f32_bf16 v58, v144, v28, v58
    v_cvt_pk_bf16_f32 v57, 0, v57
    v_dot2_f32_bf16 v58, v145, v29, v58
    v_mul_f32 v57, s74, v57
    v_dot2_f32_bf16 v58, v146, v30, v58
    v_cvt_pk_bf16_f32 v57, 0, v57
    v_dot2_f32_bf16 v58, v147, v31, v58
    s_waitcnt vmcnt(7)
    s_cmp_ge_u32 s56, 2
    s_cbranch_scc1 L_w18
    s_waitcnt vmcnt(5)
    s_cmp_ge_u32 s56, 1
    s_cbranch_scc1 L_w18
    s_waitcnt vmcnt(4)
L_w18:
    buffer_load_dwordx4 v[180:183], v2, s[28:31], s70 offen offset:256 nt
    v_add_u32 v87, 17408, v87
    v_mov_b32 v86, 1
    buffer_atomic_add v86, v87, s[44:47], 0 offen sc0 sc1
    v_dot2_f32_bf16 v59, v148, v20, 0
    v_dot2_f32_bf16 v59, v149, v21, v59
    v_dot2_f32_bf16 v59, v150, v22, v59
    v_add_f32_dpp v58, v58, v58 quad_perm:[1,0,3,2] row_mask:0xf bank_mask:0xf
    v_dot2_f32_bf16 v59, v151, v23, v59
    s_add_u32 s70, s69, 30
    s_and_b32 s70, s70, 31
    s_mul_i32 s70, s70, 49152
    s_waitcnt vmcnt(8)
    s_cmp_ge_u32 s56, 2
    s_cbranch_scc1 L_w19
    s_waitcnt vmcnt(6)
    s_cmp_ge_u32 s56, 1
    s_cbranch_scc1 L_w19
    s_waitcnt vmcnt(5)
L_w19:
    buffer_load_dwordx4 v[184:187], v2, s[28:31], s70 offen offset:0 nt
    v_dot2_f32_bf16 v59, v152, v24, v59
    v_add_f32_dpp v58, v58, v58 quad_perm:[2,3,0,1] row_mask:0xf bank_mask:0xf
    v_dot2_f32_bf16 v59, v153, v25, v59
    v_dot2_f32_bf16 v59, v154, v26, v59
    v_add_f32_dpp v58, v58, v58 row_half_mirror row_mask:0xf bank_mask:0xf
    v_dot2_f32_bf16 v59, v155, v27, v59
    s_waitcnt vmcnt(8)
    s_cmp_ge_u32 s56, 2
    s_cbranch_scc1 L_w20
    s_waitcnt vmcnt(6)
    s_cmp_ge_u32 s56, 1
    s_cbranch_scc1 L_w20
    s_waitcnt vmcnt(5)
L_w20:
    buffer_load_dwordx4 v[188:191], v2, s[28:31], s70 offen offset:128 nt
    v_dot2_f32_bf16 v59, v156, v28, v59
    v_cvt_pk_bf16_f32 v58, 0, v58
    v_dot2_f32_bf16 v59, v157, v29, v59
    v_mul_f32 v58, s74, v58
    v_dot2_f32_bf16 v59, v158, v30, v59
    v_cvt_pk_bf16_f32 v58, 0, v58
    v_dot2_f32_bf16 v59, v159, v31, v59
    s_waitcnt vmcnt(8)
    s_cmp_ge_u32 s56, 2
    s_cbranch_scc1 L_w21
    s_waitcnt vmcnt(6)
    s_cmp_ge_u32 s56, 1
    s_cbranch_scc1 L_w21
    s_waitcnt vmcnt(5)
L_w21:
    buffer_load_dwordx4 v[192:195], v2, s[28:31], s70 offen offset:256 nt
    v_dot2_f32_bf16 v60, v160, v20, 0
    v_dot2_f32_bf16 v60, v161, v21, v60
    v_dot2_f32_bf16 v60, v162, v22, v60
    v_add_f32_dpp v59, v59, v59 quad_perm:[1,0,3,2] row_mask:0xf bank_mask:0xf
    v_dot2_f32_bf16 v60, v163, v23, v60
    s_add_u32 s70, s69, 31
    s_and_b32 s70, s70, 31
    s_mul_i32 s70, s70, 49152
    s_waitcnt vmcnt(8)
    s_cmp_ge_u32 s56, 2
    s_cbranch_scc1 L_w22
    s_waitcnt vmcnt(6)
    s_cmp_ge_u32 s56, 1
    s_cbranch_scc1 L_w22
    s_waitcnt vmcnt(5)
L_w22:
    buffer_load_dwordx4 v[196:199], v2, s[28:31], s70 offen offset:0 nt
    v_dot2_f32_bf16 v60, v164, v24, v60
    v_add_f32_dpp v59, v59, v59 quad_perm:[2,3,0,1] row_mask:0xf bank_mask:0xf
    v_dot2_f32_bf16 v60, v165, v25, v60
    v_dot2_f32_bf16 v60, v166, v26, v60
    v_add_f32_dpp v59, v59, v59 row_half_mirror row_mask:0xf bank_mask:0xf
    v_dot2_f32_bf16 v60, v167, v27, v60
    s_waitcnt vmcnt(8)
    s_cmp_ge_u32 s56, 2
    s_cbranch_scc1 L_w23
    s_waitcnt vmcnt(6)
    s_cmp_ge_u32 s56, 1
    s_cbranch_scc1 L_w23
    s_waitcnt vmcnt(5)
L_w23:
    buffer_load_dwordx4 v[200:203], v2, s[28:31], s70 offen offset:128 nt
    v_dot2_f32_bf16 v60, v168, v28, v60
    v_cvt_pk_bf16_f32 v59, 0, v59
    v_dot2_f32_bf16 v60, v169, v29, v60
    v_mul_f32 v59, s74, v59
    v_dot2_f32_bf16 v60, v170, v30, v60
    v_cvt_pk_bf16_f32 v59, 0, v59
    v_dot2_f32_bf16 v60, v171, v31, v60
    s_waitcnt vmcnt(8)
    s_cmp_ge_u32 s56, 2
    s_cbranch_scc1 L_w24
    s_waitcnt vmcnt(6)
L_w24:
    buffer_load_dwordx4 v[204:207], v2, s[28:31], s70 offen offset:256 nt
    v_dot2_f32_bf16 v61, v172, v20, 0
    v_dot2_f32_bf16 v61, v173, v21, v61
    v_dot2_f32_bf16 v61, v174, v22, v61
    v_add_f32_dpp v60, v60, v60 quad_perm:[1,0,3,2] row_mask:0xf bank_mask:0xf
    v_dot2_f32_bf16 v61, v175, v23, v61
    s_mul_i32 s70, s69, 49152
    s_waitcnt vmcnt(8)
    s_cmp_ge_u32 s56, 2
    s_cbranch_scc1 L_w25
    s_waitcnt vmcnt(7)
L_w25:
    buffer_load_dwordx4 a[36:39], v2, s[32:35], s70 offen offset:0 nt
    v_dot2_f32_bf16 v61, v176, v24, v61
    v_add_f32_dpp v60, v60, v60 quad_perm:[2,3,0,1] row_mask:0xf bank_mask:0xf
    v_dot2_f32_bf16 v61, v177, v25, v61
    v_dot2_f32_bf16 v61, v178, v26, v61
    v_add_f32_dpp v60, v60, v60 row_half_mirror row_mask:0xf bank_mask:0xf
    v_dot2_f32_bf16 v61, v179, v27, v61
    s_waitcnt vmcnt(8)
    s_cmp_ge_u32 s56, 2
    s_cbranch_scc1 L_w26
    s_waitcnt vmcnt(5)
    s_cmp_ge_u32 s56, 1
    s_cbranch_scc1 L_w26
    s_waitcnt vmcnt(4)
L_w26:
    buffer_load_dwordx4 a[40:43], v2, s[32:35], s70 offen offset:128 nt
    v_dot2_f32_bf16 v61, v180, v28, v61
    v_cvt_pk_bf16_f32 v60, 0, v60
    v_dot2_f32_bf16 v61, v181, v29, v61
    v_mul_f32 v60, s74, v60
    v_dot2_f32_bf16 v61, v182, v30, v61
    v_cvt_pk_bf16_f32 v60, 0, v60
    v_dot2_f32_bf16 v61, v183, v31, v61
    s_waitcnt vmcnt(7)
    s_cmp_ge_u32 s56, 2
    s_cbranch_scc1 L_w27
    s_waitcnt vmcnt(5)
    s_cmp_ge_u32 s56, 1
    s_cbranch_scc1 L_w27
    s_waitcnt vmcnt(4)
L_w27:
    buffer_load_dwordx4 a[44:47], v2, s[32:35], s70 offen offset:256 nt
    s_mov_b64 exec, 1
    ds_write_b32 v17, v86 offset:16944
    s_mov_b64 exec, -1
    v_dot2_f32_bf16 v62, v184, v20, 0
    v_dot2_f32_bf16 v62, v185, v21, v62
    v_dot2_f32_bf16 v62, v186, v22, v62
    v_add_f32_dpp v61, v61, v61 quad_perm:[1,0,3,2] row_mask:0xf bank_mask:0xf
    v_dot2_f32_bf16 v62, v187, v23, v62
    s_add_u32 s70, s69, 1
    s_and_b32 s70, s70, 31
    s_mul_i32 s70, s70, 49152
    s_waitcnt vmcnt(7)
    s_cmp_ge_u32 s56, 2
    s_cbranch_scc1 L_w28
    s_waitcnt vmcnt(5)
    s_cmp_ge_u32 s56, 1
    s_cbranch_scc1 L_w28
    s_waitcnt vmcnt(4)
L_w28:
    buffer_load_dwordx4 a[48:51], v2, s[32:35], s70 offen offset:0 nt
    buffer_load_dwordx4 v[80:83], v18, s[44:47], 0 offen sc1
    v_dot2_f32_bf16 v62, v188, v24, v62
    v_add_f32_dpp v61, v61, v61 quad_perm:[2,3,0,1] row_mask:0xf bank_mask:0xf
    v_dot2_f32_bf16 v62, v189, v25, v62
    v_dot2_f32_bf16 v62, v190, v26, v62
    v_add_f32_dpp v61, v61, v61 row_half_mirror row_mask:0xf bank_mask:0xf
    v_dot2_f32_bf16 v62, v191, v27, v62
    s_waitcnt vmcnt(7)
    s_cmp_ge_u32 s56, 2
    s_cbranch_scc1 L_w29
    s_waitcnt vmcnt(5)
    s_cmp_ge_u32 s56, 1
    s_cbranch_scc1 L_w29
    s_waitcnt vmcnt(4)
L_w29:
    buffer_load_dwordx4 a[52:55], v2, s[32:35], s70 offen offset:128 nt
    v_dot2_f32_bf16 v62, v192, v28, v62
    v_cvt_pk_bf16_f32 v61, 0, v61
    v_dot2_f32_bf16 v62, v193, v29, v62
    v_mul_f32 v61, s74, v61
    v_dot2_f32_bf16 v62, v194, v30, v62
    v_cvt_pk_bf16_f32 v61, 0, v61
    v_dot2_f32_bf16 v62, v195, v31, v62
    v_dot2_f32_bf16 v63, v196, v20, 0
    v_dot2_f32_bf16 v63, v197, v21, v63
    v_dot2_f32_bf16 v63, v198, v22, v63
    v_add_f32_dpp v62, v62, v62 quad_perm:[1,0,3,2] row_mask:0xf bank_mask:0xf
    v_dot2_f32_bf16 v63, v199, v23, v63
    s_waitcnt vmcnt(7)
    s_cmp_ge_u32 s56, 2
    s_cbranch_scc1 L_w30
    s_waitcnt vmcnt(5)
    s_cmp_ge_u32 s56, 1
    s_cbranch_scc1 L_w30
    s_waitcnt vmcnt(4)
L_w30:
    buffer_load_dwordx4 a[56:59], v2, s[32:35], s70 offen offset:256 nt
    ds_read_b32 v86, v14 offset:16944
    v_dot2_f32_bf16 v63, v200, v24, v63
    v_add_f32_dpp v62, v62, v62 quad_perm:[2,3,0,1] row_mask:0xf bank_mask:0xf
    v_dot2_f32_bf16 v63, v201, v25, v63
    v_dot2_f32_bf16 v63, v202, v26, v63
    v_add_f32_dpp v62, v62, v62 row_half_mirror row_mask:0xf bank_mask:0xf
    v_dot2_f32_bf16 v63, v203, v27, v63
    s_add_u32 s70, s69, 2
    s_and_b32 s70, s70, 31
    s_mul_i32 s70, s70, 49152
    s_waitcnt vmcnt(7)
    s_cmp_ge_u32 s56, 2
    s_cbranch_scc1 L_w31
    s_waitcnt vmcnt(5)
    s_cmp_ge_u32 s56, 1
    s_cbranch_scc1 L_w31
    s_waitcnt vmcnt(4)
L_w31:
    buffer_load_dwordx4 a[60:63], v2, s[32:35], s70 offen offset:0 nt
    s_waitcnt lgkmcnt(0)
    v_readfirstlane_b32 s57, v86
    s_mov_b32 s56, 0
    s_cmp_ge_i32 s57, 31
    s_addc_u32 s56, s56, 0
    s_cmp_ge_i32 s57, 51
    s_addc_u32 s56, s56, 0
    v_dot2_f32_bf16 v63, v204, v28, v63
    v_cvt_pk_bf16_f32 v62, 0, v62
    v_dot2_f32_bf16 v63, v205, v29, v63
    v_mul_f32 v62, s74, v62
    v_dot2_f32_bf16 v63, v206, v30, v63
    v_cvt_pk_bf16_f32 v62, 0, v62
    v_dot2_f32_bf16 v63, v207, v31, v63
    s_nop 2
    v_add_f32_dpp v63, v63, v63 quad_perm:[1,0,3,2] row_mask:0xf bank_mask:0xf
    s_nop 1
    v_add_f32_dpp v63, v63, v63 quad_perm:[2,3,0,1] row_mask:0xf bank_mask:0xf
    s_nop 1
    v_add_f32_dpp v63, v63, v63 row_half_mirror row_mask:0xf bank_mask:0xf
    v_cvt_pk_bf16_f32 v63, 0, v63
    v_mul_f32 v63, s74, v63
    v_cvt_pk_bf16_f32 v63, 0, v63
    v_max3_f32 v7, v32, v33, v34
    v_max3_f32 v15, v35, v36, v37
    v_max3_f32 v7, v7, v38, v39
    v_max3_f32 v15, v15, v40, v41
    v_max3_f32 v7, v7, v42, v43
    v_max3_f32 v15, v15, v44, v45
    v_max3_f32 v7, v7, v46, v47
    v_max3_f32 v15, v15, v48, v49
    v_max3_f32 v7, v7, v50, v51
    v_max3_f32 v15, v15, v52, v53
    v_max3_f32 v7, v7, v54, v55
    v_max3_f32 v15, v15, v56, v57
    v_max3_f32 v7, v7, v58, v59
    v_max3_f32 v15, v15, v60, v61
    v_max3_f32 v7, v7, v62, v63
    v_max_f32 v76, v7, v15
    s_nop 1
    v_max_f32_dpp v76, v76, v76 row_ror:8 row_mask:0xf bank_mask:0xf
    v_mov_b32 v15, v76
    s_nop 1
    v_permlane16_swap_b32 v76, v15
    v_max_f32 v76, v76, v15
    v_mov_b32 v15, v76
    s_nop 1
    v_permlane32_swap_b32 v76, v15
    v_max_f32 v76, v76, v15
    v_mul_f32 v77, s76, v76
    v_mov_b32 v78, 0
    v_mov_b32 v79, 0
    s_waitcnt vmcnt(7)
    s_cmp_ge_u32 s56, 2
    s_cbranch_scc1 L_w32
    s_waitcnt vmcnt(5)
    s_cmp_ge_u32 s56, 1
    s_cbranch_scc1 L_w32
    s_waitcnt vmcnt(4)
L_w32:
    buffer_load_dwordx4 a[64:67], v2, s[32:35], s70 offen offset:128 nt
    v_fma_f32 v32, v32, s76, -v77
    v_fma_f32 v33, v33, s76, -v77
    v_fma_f32 v34, v34, s76, -v77
    v_fma_f32 v35, v35, s76, -v77
    v_exp_f32 v32, v32
    v_exp_f32 v33, v33
    v_exp_f32 v34, v34
    v_exp_f32 v35, v35
    v_add_f32 v78, v78, v32
    v_add_f32 v79, v79, v33
    v_add_f32 v78, v78, v34
    v_add_f32 v79, v79, v35
    v_cvt_pk_bf16_f32 v32, v32, v32
    v_cvt_pk_bf16_f32 v33, v33, v33
    v_cvt_pk_bf16_f32 v34, v34, v34
    v_cvt_pk_bf16_f32 v35, v35, v35
    v_fma_f32 v36, v36, s76, -v77
    v_fma_f32 v37, v37, s76, -v77
    v_fma_f32 v38, v38, s76, -v77
    v_fma_f32 v39, v39, s76, -v77
    v_exp_f32 v36, v36
    v_exp_f32 v37, v37
    v_exp_f32 v38, v38
    v_exp_f32 v39, v39
    v_add_f32 v78, v78, v36
    v_add_f32 v79, v79, v37
    v_add_f32 v78, v78, v38
    v_add_f32 v79, v79, v39
    v_cvt_pk_bf16_f32 v36, v36, v36
    v_cvt_pk_bf16_f32 v37, v37, v37
    v_cvt_pk_bf16_f32 v38, v38, v38
    v_cvt_pk_bf16_f32 v39, v39, v39
    s_waitcnt vmcnt(7)
    s_cmp_ge_u32 s56, 2
    s_cbranch_scc1 L_w33
    s_waitcnt vmcnt(5)
    s_cmp_ge_u32 s56, 1
    s_cbranch_scc1 L_w33
    s_waitcnt vmcnt(4)
L_w33:
    buffer_load_dwordx4 a[68:71], v2, s[32:35], s70 offen offset:256 nt
    v_fma_f32 v40, v40, s76, -v77
    v_fma_f32 v41, v41, s76, -v77
    v_fma_f32 v42, v42, s76, -v77
    v_fma_f32 v43, v43, s76, -v77
    v_exp_f32 v40, v40
    v_exp_f32 v41, v41
    v_exp_f32 v42, v42
    v_exp_f32 v43, v43
    v_add_f32 v78, v78, v40
    v_add_f32 v79, v79, v41
    v_add_f32 v78, v78, v42
    v_add_f32 v79, v79, v43
    v_cvt_pk_bf16_f32 v40, v40, v40
    v_cvt_pk_bf16_f32 v41, v41, v41
    v_cvt_pk_bf16_f32 v42, v42, v42
    v_cvt_pk_bf16_f32 v43, v43, v43
    v_fma_f32 v44, v44, s76, -v77
    v_fma_f32 v45, v45, s76, -v77
    v_fma_f32 v46, v46, s76, -v77
    v_fma_f32 v47, v47, s76, -v77
    v_exp_f32 v44, v44
    v_exp_f32 v45, v45
    v_exp_f32 v46, v46
    v_exp_f32 v47, v47
    v_add_f32 v78, v78, v44
    v_add_f32 v79, v79, v45
    v_add_f32 v78, v78, v46
    v_add_f32 v79, v79, v47
    v_cvt_pk_bf16_f32 v44, v44, v44
    v_cvt_pk_bf16_f32 v45, v45, v45
    v_cvt_pk_bf16_f32 v46, v46, v46
    v_cvt_pk_bf16_f32 v47, v47, v47
    s_add_u32 s70, s69, 3
    s_and_b32 s70, s70, 31
    s_mul_i32 s70, s70, 49152
    s_waitcnt vmcnt(7)
    s_cmp_ge_u32 s56, 2
    s_cbranch_scc1 L_w34
    s_waitcnt vmcnt(5)
    s_cmp_ge_u32 s56, 1
    s_cbranch_scc1 L_w34
    s_waitcnt vmcnt(4)
L_w34:
    buffer_load_dwordx4 a[72:75], v2, s[32:35], s70 offen offset:0 nt
    v_fma_f32 v48, v48, s76, -v77
    v_fma_f32 v49, v49, s76, -v77
    v_fma_f32 v50, v50, s76, -v77
    v_fma_f32 v51, v51, s76, -v77
    v_exp_f32 v48, v48
    v_exp_f32 v49, v49
    v_exp_f32 v50, v50
    v_exp_f32 v51, v51
    v_add_f32 v78, v78, v48
    v_add_f32 v79, v79, v49
    v_add_f32 v78, v78, v50
    v_add_f32 v79, v79, v51
    v_cvt_pk_bf16_f32 v48, v48, v48
    v_cvt_pk_bf16_f32 v49, v49, v49
    v_cvt_pk_bf16_f32 v50, v50, v50
    v_cvt_pk_bf16_f32 v51, v51, v51
    v_fma_f32 v52, v52, s76, -v77
    v_fma_f32 v53, v53, s76, -v77
    v_fma_f32 v54, v54, s76, -v77
    v_fma_f32 v55, v55, s76, -v77
    v_exp_f32 v52, v52
    v_exp_f32 v53, v53
    v_exp_f32 v54, v54
    v_exp_f32 v55, v55
    v_add_f32 v78, v78, v52
    v_add_f32 v79, v79, v53
    v_add_f32 v78, v78, v54
    v_add_f32 v79, v79, v55
    v_cvt_pk_bf16_f32 v52, v52, v52
    v_cvt_pk_bf16_f32 v53, v53, v53
    v_cvt_pk_bf16_f32 v54, v54, v54
    v_cvt_pk_bf16_f32 v55, v55, v55
    s_waitcnt vmcnt(7)
    s_cmp_ge_u32 s56, 2
    s_cbranch_scc1 L_w35
    s_waitcnt vmcnt(5)
    s_cmp_ge_u32 s56, 1
    s_cbranch_scc1 L_w35
    s_waitcnt vmcnt(4)
L_w35:
    buffer_load_dwordx4 a[76:79], v2, s[32:35], s70 offen offset:128 nt
    ds_read_b32 v86, v14 offset:16944
    v_fma_f32 v56, v56, s76, -v77
    v_fma_f32 v57, v57, s76, -v77
    v_fma_f32 v58, v58, s76, -v77
    v_fma_f32 v59, v59, s76, -v77
    v_exp_f32 v56, v56
    v_exp_f32 v57, v57
    v_exp_f32 v58, v58
    v_exp_f32 v59, v59
    v_add_f32 v78, v78, v56
    v_add_f32 v79, v79, v57
    v_add_f32 v78, v78, v58
    v_add_f32 v79, v79, v59
    v_cvt_pk_bf16_f32 v56, v56, v56
    v_cvt_pk_bf16_f32 v57, v57, v57
    v_cvt_pk_bf16_f32 v58, v58, v58
    v_cvt_pk_bf16_f32 v59, v59, v59
    v_fma_f32 v60, v60, s76, -v77
    v_fma_f32 v61, v61, s76, -v77
    v_fma_f32 v62, v62, s76, -v77
    v_fma_f32 v63, v63, s76, -v77
    v_exp_f32 v60, v60
    v_exp_f32 v61, v61
    v_exp_f32 v62, v62
    v_exp_f32 v63, v63
    v_add_f32 v78, v78, v60
    v_add_f32 v79, v79, v61
    v_add_f32 v78, v78, v62
    v_add_f32 v79, v79, v63
    v_cvt_pk_bf16_f32 v60, v60, v60
    v_cvt_pk_bf16_f32 v61, v61, v61
    v_cvt_pk_bf16_f32 v62, v62, v62
    v_cvt_pk_bf16_f32 v63, v63, v63
    s_waitcnt vmcnt(7)
    s_cmp_ge_u32 s56, 2
    s_cbranch_scc1 L_w36
    s_waitcnt vmcnt(5)
    s_cmp_ge_u32 s56, 1
    s_cbranch_scc1 L_w36
    s_waitcnt vmcnt(4)
L_w36:
    buffer_load_dwordx4 a[80:83], v2, s[32:35], s70 offen offset:256 nt
    s_waitcnt lgkmcnt(0)
    v_readfirstlane_b32 s57, v86
    s_mov_b32 s56, 0
    s_cmp_ge_i32 s57, 31
    s_addc_u32 s56, s56, 0
    s_cmp_ge_i32 s57, 51
    s_addc_u32 s56, s56, 0
    v_max3_u32 v84, v80, v81, v82
    v_max_u32 v84, v84, v83
    v_cmp_eq_u32 vcc, -1, v84
    s_mov_b32 s75, 0
    s_cbranch_vccz L_alok
L_alspin:
    buffer_load_dwordx4 v[80:83], v18, s[44:47], 0 offen sc1
    s_add_u32 s75, s75, 1
    s_waitcnt vmcnt(0)
    v_max3_u32 v84, v80, v81, v82
    v_max_u32 v84, v84, v83
    v_cmp_eq_u32 vcc, -1, v84
    s_cbranch_vccz L_alok
    s_cmp_lt_u32 s75, 4194304
    s_cbranch_scc1 L_alspin
L_alok:
    v_add3_u32 v84, v80, v81, v82
    v_add_u32 v84, v84, v83
    s_nop 1
    v_add_u32_dpp v84, v84, v84 quad_perm:[1,0,3,2] row_mask:0xf bank_mask:0xf
    s_nop 1
    v_add_u32_dpp v84, v84, v84 quad_perm:[2,3,0,1] row_mask:0xf bank_mask:0xf
    s_nop 1
    v_add_u32_dpp v84, v84, v84 row_half_mirror row_mask:0xf bank_mask:0xf
    s_nop 1
    v_add_u32_dpp v84, v84, v84 row_mirror row_mask:0xf bank_mask:0xf
    s_nop 0
    v_readlane_b32 s8, v84, 0
    v_readlane_b32 s9, v84, 16
    v_readlane_b32 s10, v84, 32
    v_readlane_b32 s11, v84, 48
    s_add_u32 s8, s8, s9
    s_add_u32 s10, s10, s11
    s_add_u32 s11, s8, s10
    s_sub_u32 s11, s11, 4096
    s_lshr_b32 s8, s11, 31
    s_xor_b32 s38, s38, s8
    s_lshl_b32 s38, s38, 13
    s_xor_b32 s39, s38, 8192
    s_lshr_b32 s72, s66, 1
    s_and_b32 s71, s66, 1
    s_lshl2_add_u32 s71, s72, s71
    s_lshl_b32 s71, s71, 12
    s_add_u32 s71, s71, 524288
    s_lshl_b32 s72, s68, 6
    s_add_u32 s71, s71, s72
    v_lshrrev_b32 v12, 4, v0
    v_and_b32 v13, 15, v0
    v_lshlrev_b32 v12, 9, v12
    v_lshl_add_u32 v12, v13, 2, v12
    v_cmp_gt_u32 vcc, 96, v0
    v_add_u32 v12, s71, v12
    v_lshlrev_b32 v13, 3, v0
    v_cndmask_b32 v12, v16, v12, vcc
    v_add_u32 v13, 0, v13
    v_and_b32 v8, v32, v3
    v_and_b32 v9, v32, v4
    v_and_b32 v10, v32, v5
    v_and_b32 v11, v32, v6
    s_nop 1
    v_mfma_f32_16x16x32_bf16 v[64:67], v[8:11], a[36:39], 0
    v_mfma_f32_16x16x32_bf16 v[68:71], v[8:11], a[40:43], 0
    v_mfma_f32_16x16x32_bf16 v[72:75], v[8:11], a[44:47], 0
    v_and_b32 v8, v33, v3
    v_and_b32 v9, v33, v4
    v_and_b32 v10, v33, v5
    v_and_b32 v11, v33, v6
    s_nop 1
    v_mfma_f32_16x16x32_bf16 v[64:67], v[8:11], a[48:51], v[64:67]
    s_add_u32 s70, s69, 4
    s_and_b32 s70, s70, 31
    s_mul_i32 s70, s70, 49152
    s_waitcnt vmcnt(7)
    s_cmp_ge_u32 s56, 2
    s_cbranch_scc1 L_w37
    s_waitcnt vmcnt(5)
    s_cmp_ge_u32 s56, 1
    s_cbranch_scc1 L_w37
    s_waitcnt vmcnt(4)
L_w37:
    buffer_load_dwordx4 a[84:87], v2, s[32:35], s70 offen offset:0 nt
    v_mfma_f32_16x16x32_bf16 v[68:71], v[8:11], a[52:55], v[68:71]
    s_waitcnt vmcnt(7)
    s_cmp_ge_u32 s56, 2
    s_cbranch_scc1 L_w38
    s_waitcnt vmcnt(5)
    s_cmp_ge_u32 s56, 1
    s_cbranch_scc1 L_w38
    s_waitcnt vmcnt(4)
L_w38:
    buffer_load_dwordx4 a[88:91], v2, s[32:35], s70 offen offset:128 nt
    v_mfma_f32_16x16x32_bf16 v[72:75], v[8:11], a[56:59], v[72:75]
    s_waitcnt vmcnt(7)
    s_cmp_ge_u32 s56, 2
    s_cbranch_scc1 L_w39
    s_waitcnt vmcnt(5)
    s_cmp_ge_u32 s56, 1
    s_cbranch_scc1 L_w39
    s_waitcnt vmcnt(4)
L_w39:
    buffer_load_dwordx4 a[92:95], v2, s[32:35], s70 offen offset:256 nt
    v_and_b32 v8, v34, v3
    v_and_b32 v9, v34, v4
    v_and_b32 v10, v34, v5
    v_and_b32 v11, v34, v6
    s_nop 1
    v_mfma_f32_16x16x32_bf16 v[64:67], v[8:11], a[60:63], v[64:67]
    s_add_u32 s70, s69, 5
    s_and_b32 s70, s70, 31
    s_mul_i32 s70, s70, 49152
    s_waitcnt vmcnt(7)
    s_cmp_ge_u32 s56, 2
    s_cbranch_scc1 L_w40
    s_waitcnt vmcnt(5)
    s_cmp_ge_u32 s56, 1
    s_cbranch_scc1 L_w40
    s_waitcnt vmcnt(4)
L_w40:
    buffer_load_dwordx4 a[96:99], v2, s[32:35], s70 offen offset:0 nt
    v_mfma_f32_16x16x32_bf16 v[68:71], v[8:11], a[64:67], v[68:71]
    s_waitcnt vmcnt(7)
    s_cmp_ge_u32 s56, 2
    s_cbranch_scc1 L_w41
    s_waitcnt vmcnt(5)
    s_cmp_ge_u32 s56, 1
    s_cbranch_scc1 L_w41
    s_waitcnt vmcnt(4)
L_w41:
    buffer_load_dwordx4 a[100:103], v2, s[32:35], s70 offen offset:128 nt
    v_mfma_f32_16x16x32_bf16 v[72:75], v[8:11], a[68:71], v[72:75]
    s_waitcnt vmcnt(7)
    s_cmp_ge_u32 s56, 2
    s_cbranch_scc1 L_w42
    s_waitcnt vmcnt(5)
    s_cmp_ge_u32 s56, 1
    s_cbranch_scc1 L_w42
    s_waitcnt vmcnt(4)
L_w42:
    buffer_load_dwordx4 a[104:107], v2, s[32:35], s70 offen offset:256 nt
    v_and_b32 v8, v35, v3
    v_and_b32 v9, v35, v4
    v_and_b32 v10, v35, v5
    v_and_b32 v11, v35, v6
    s_nop 1
    v_mfma_f32_16x16x32_bf16 v[64:67], v[8:11], a[72:75], v[64:67]
    s_add_u32 s70, s69, 6
    s_and_b32 s70, s70, 31
    s_mul_i32 s70, s70, 49152
    s_waitcnt vmcnt(7)
    s_cmp_ge_u32 s56, 2
    s_cbranch_scc1 L_w43
    s_waitcnt vmcnt(5)
    s_cmp_ge_u32 s56, 1
    s_cbranch_scc1 L_w43
    s_waitcnt vmcnt(4)
L_w43:
    buffer_load_dwordx4 a[108:111], v2, s[32:35], s70 offen offset:0 nt
    v_mfma_f32_16x16x32_bf16 v[68:71], v[8:11], a[76:79], v[68:71]
    s_waitcnt vmcnt(7)
    s_cmp_ge_u32 s56, 2
    s_cbranch_scc1 L_w44
    s_waitcnt vmcnt(5)
    s_cmp_ge_u32 s56, 1
    s_cbranch_scc1 L_w44
    s_waitcnt vmcnt(4)
L_w44:
    buffer_load_dwordx4 a[112:115], v2, s[32:35], s70 offen offset:128 nt
    v_mfma_f32_16x16x32_bf16 v[72:75], v[8:11], a[80:83], v[72:75]
    s_waitcnt vmcnt(7)
    s_cmp_ge_u32 s56, 2
    s_cbranch_scc1 L_w45
    s_waitcnt vmcnt(5)
    s_cmp_ge_u32 s56, 1
    s_cbranch_scc1 L_w45
    s_waitcnt vmcnt(4)
L_w45:
    buffer_load_dwordx4 a[116:119], v2, s[32:35], s70 offen offset:256 nt
    v_and_b32 v8, v36, v3
    v_and_b32 v9, v36, v4
    v_and_b32 v10, v36, v5
    v_and_b32 v11, v36, v6
    s_nop 1
    v_mfma_f32_16x16x32_bf16 v[64:67], v[8:11], a[84:87], v[64:67]
    s_add_u32 s70, s69, 7
    s_and_b32 s70, s70, 31
    s_mul_i32 s70, s70, 49152
    s_waitcnt vmcnt(7)
    s_cmp_ge_u32 s56, 2
    s_cbranch_scc1 L_w46
    s_waitcnt vmcnt(5)
    s_cmp_ge_u32 s56, 1
    s_cbranch_scc1 L_w46
    s_waitcnt vmcnt(4)
L_w46:
    buffer_load_dwordx4 a[120:123], v2, s[32:35], s70 offen offset:0 nt
    v_mfma_f32_16x16x32_bf16 v[68:71], v[8:11], a[88:91], v[68:71]
    s_waitcnt vmcnt(7)
    s_cmp_ge_u32 s56, 2
    s_cbranch_scc1 L_w47
    s_waitcnt vmcnt(5)
    s_cmp_ge_u32 s56, 1
    s_cbranch_scc1 L_w47
    s_waitcnt vmcnt(4)
L_w47:
    buffer_load_dwordx4 a[124:127], v2, s[32:35], s70 offen offset:128 nt
    v_mfma_f32_16x16x32_bf16 v[72:75], v[8:11], a[92:95], v[72:75]
    s_waitcnt vmcnt(7)
    s_cmp_ge_u32 s56, 2
    s_cbranch_scc1 L_w48
    s_waitcnt vmcnt(5)
    s_cmp_ge_u32 s56, 1
    s_cbranch_scc1 L_w48
    s_waitcnt vmcnt(4)
L_w48:
    buffer_load_dwordx4 a[128:131], v2, s[32:35], s70 offen offset:256 nt
    v_add_u32 v87, 17408, v87
    v_mov_b32 v86, 1
    buffer_atomic_add v86, v87, s[44:47], 0 offen sc0 sc1
    v_and_b32 v8, v37, v3
    v_and_b32 v9, v37, v4
    v_and_b32 v10, v37, v5
    v_and_b32 v11, v37, v6
    s_nop 1
    v_mfma_f32_16x16x32_bf16 v[64:67], v[8:11], a[96:99], v[64:67]
    s_add_u32 s70, s69, 8
    s_and_b32 s70, s70, 31
    s_mul_i32 s70, s70, 49152
    s_waitcnt vmcnt(8)
    s_cmp_ge_u32 s56, 2
    s_cbranch_scc1 L_w49
    s_waitcnt vmcnt(6)
    s_cmp_ge_u32 s56, 1
    s_cbranch_scc1 L_w49
    s_waitcnt vmcnt(5)
L_w49:
    buffer_load_dwordx4 a[132:135], v2, s[32:35], s70 offen offset:0 nt
    v_mfma_f32_16x16x32_bf16 v[68:71], v[8:11], a[100:103], v[68:71]
    s_waitcnt vmcnt(8)
    s_cmp_ge_u32 s56, 2
    s_cbranch_scc1 L_w50
    s_waitcnt vmcnt(6)
    s_cmp_ge_u32 s56, 1
    s_cbranch_scc1 L_w50
    s_waitcnt vmcnt(5)
L_w50:
    buffer_load_dwordx4 a[136:139], v2, s[32:35], s70 offen offset:128 nt
    v_mfma_f32_16x16x32_bf16 v[72:75], v[8:11], a[104:107], v[72:75]
    s_waitcnt vmcnt(8)
    s_cmp_ge_u32 s56, 2
    s_cbranch_scc1 L_w51
    s_waitcnt vmcnt(6)
    s_cmp_ge_u32 s56, 1
    s_cbranch_scc1 L_w51
    s_waitcnt vmcnt(5)
L_w51:
    buffer_load_dwordx4 a[140:143], v2, s[32:35], s70 offen offset:256 nt
    v_and_b32 v8, v38, v3
    v_and_b32 v9, v38, v4
    v_and_b32 v10, v38, v5
    v_and_b32 v11, v38, v6
    s_nop 1
    v_mfma_f32_16x16x32_bf16 v[64:67], v[8:11], a[108:111], v[64:67]
    s_add_u32 s70, s69, 9
    s_and_b32 s70, s70, 31
    s_mul_i32 s70, s70, 49152
    s_waitcnt vmcnt(8)
    s_cmp_ge_u32 s56, 2
    s_cbranch_scc1 L_w52
    s_waitcnt vmcnt(6)
    s_cmp_ge_u32 s56, 1
    s_cbranch_scc1 L_w52
    s_waitcnt vmcnt(5)
L_w52:
    buffer_load_dwordx4 a[144:147], v2, s[32:35], s70 offen offset:0 nt
    v_mfma_f32_16x16x32_bf16 v[68:71], v[8:11], a[112:115], v[68:71]
    s_waitcnt vmcnt(8)
    s_cmp_ge_u32 s56, 2
    s_cbranch_scc1 L_w53
    s_waitcnt vmcnt(6)
    s_cmp_ge_u32 s56, 1
    s_cbranch_scc1 L_w53
    s_waitcnt vmcnt(5)
L_w53:
    buffer_load_dwordx4 a[148:151], v2, s[32:35], s70 offen offset:128 nt
    v_mfma_f32_16x16x32_bf16 v[72:75], v[8:11], a[116:119], v[72:75]
    s_waitcnt vmcnt(8)
    s_cmp_ge_u32 s56, 2
    s_cbranch_scc1 L_w54
    s_waitcnt vmcnt(6)
L_w54:
    buffer_load_dwordx4 a[152:155], v2, s[32:35], s70 offen offset:256 nt
    v_and_b32 v8, v39, v3
    v_and_b32 v9, v39, v4
    v_and_b32 v10, v39, v5
    v_and_b32 v11, v39, v6
    s_nop 1
    v_mfma_f32_16x16x32_bf16 v[64:67], v[8:11], a[120:123], v[64:67]
    s_add_u32 s70, s69, 10
    s_and_b32 s70, s70, 31
    s_mul_i32 s70, s70, 49152
    s_waitcnt vmcnt(8)
    s_cmp_ge_u32 s56, 2
    s_cbranch_scc1 L_w55
    s_waitcnt vmcnt(7)
L_w55:
    buffer_load_dwordx4 a[156:159], v2, s[32:35], s70 offen offset:0 nt
    v_mfma_f32_16x16x32_bf16 v[68:71], v[8:11], a[124:127], v[68:71]
    s_waitcnt vmcnt(8)
    s_cmp_ge_u32 s56, 2
    s_cbranch_scc1 L_w56
    s_waitcnt vmcnt(5)
    s_cmp_ge_u32 s56, 1
    s_cbranch_scc1 L_w56
    s_waitcnt vmcnt(4)
L_w56:
    buffer_load_dwordx4 a[160:163], v2, s[32:35], s70 offen offset:128 nt
    v_mfma_f32_16x16x32_bf16 v[72:75], v[8:11], a[128:131], v[72:75]
    s_waitcnt vmcnt(7)
    s_cmp_ge_u32 s56, 2
    s_cbranch_scc1 L_w57
    s_waitcnt vmcnt(5)
    s_cmp_ge_u32 s56, 1
    s_cbranch_scc1 L_w57
    s_waitcnt vmcnt(4)
L_w57:
    buffer_load_dwordx4 a[164:167], v2, s[32:35], s70 offen offset:256 nt
    s_mov_b64 exec, 1
    ds_write_b32 v17, v86 offset:16944
    s_mov_b64 exec, -1
    v_and_b32 v8, v40, v3
    v_and_b32 v9, v40, v4
    v_and_b32 v10, v40, v5
    v_and_b32 v11, v40, v6
    s_nop 1
    v_mfma_f32_16x16x32_bf16 v[64:67], v[8:11], a[132:135], v[64:67]
    s_add_u32 s70, s69, 11
    s_and_b32 s70, s70, 31
    s_mul_i32 s70, s70, 49152
    s_waitcnt vmcnt(7)
    s_cmp_ge_u32 s56, 2
    s_cbranch_scc1 L_w58
    s_waitcnt vmcnt(5)
    s_cmp_ge_u32 s56, 1
    s_cbranch_scc1 L_w58
    s_waitcnt vmcnt(4)
L_w58:
    buffer_load_dwordx4 a[168:171], v2, s[32:35], s70 offen offset:0 nt
    v_mfma_f32_16x16x32_bf16 v[68:71], v[8:11], a[136:139], v[68:71]
    s_waitcnt vmcnt(7)
    s_cmp_ge_u32 s56, 2
    s_cbranch_scc1 L_w59
    s_waitcnt vmcnt(5)
    s_cmp_ge_u32 s56, 1
    s_cbranch_scc1 L_w59
    s_waitcnt vmcnt(4)
L_w59:
    buffer_load_dwordx4 a[172:175], v2, s[32:35], s70 offen offset:128 nt
    v_mfma_f32_16x16x32_bf16 v[72:75], v[8:11], a[140:143], v[72:75]
    s_waitcnt vmcnt(7)
    s_cmp_ge_u32 s56, 2
    s_cbranch_scc1 L_w60
    s_waitcnt vmcnt(5)
    s_cmp_ge_u32 s56, 1
    s_cbranch_scc1 L_w60
    s_waitcnt vmcnt(4)
L_w60:
    buffer_load_dwordx4 a[176:179], v2, s[32:35], s70 offen offset:256 nt
    ds_read_b32 v86, v14 offset:16944
    v_and_b32 v8, v41, v3
    v_and_b32 v9, v41, v4
    v_and_b32 v10, v41, v5
    v_and_b32 v11, v41, v6
    s_nop 1
    v_mfma_f32_16x16x32_bf16 v[64:67], v[8:11], a[144:147], v[64:67]
    s_add_u32 s70, s69, 12
    s_and_b32 s70, s70, 31
    s_mul_i32 s70, s70, 49152
    s_waitcnt vmcnt(7)
    s_cmp_ge_u32 s56, 2
    s_cbranch_scc1 L_w61
    s_waitcnt vmcnt(5)
    s_cmp_ge_u32 s56, 1
    s_cbranch_scc1 L_w61
    s_waitcnt vmcnt(4)
L_w61:
    buffer_load_dwordx4 a[180:183], v2, s[32:35], s70 offen offset:0 nt
    s_waitcnt lgkmcnt(0)
    v_readfirstlane_b32 s57, v86
    s_mov_b32 s56, 0
    s_cmp_ge_i32 s57, 31
    s_addc_u32 s56, s56, 0
    s_cmp_ge_i32 s57, 51
    s_addc_u32 s56, s56, 0
    v_mfma_f32_16x16x32_bf16 v[68:71], v[8:11], a[148:151], v[68:71]
    s_waitcnt vmcnt(7)
    s_cmp_ge_u32 s56, 2
    s_cbranch_scc1 L_w62
    s_waitcnt vmcnt(5)
    s_cmp_ge_u32 s56, 1
    s_cbranch_scc1 L_w62
    s_waitcnt vmcnt(4)
L_w62:
    buffer_load_dwordx4 a[184:187], v2, s[32:35], s70 offen offset:128 nt
    v_mfma_f32_16x16x32_bf16 v[72:75], v[8:11], a[152:155], v[72:75]
    s_waitcnt vmcnt(7)
    s_cmp_ge_u32 s56, 2
    s_cbranch_scc1 L_w63
    s_waitcnt vmcnt(5)
    s_cmp_ge_u32 s56, 1
    s_cbranch_scc1 L_w63
    s_waitcnt vmcnt(4)
L_w63:
    buffer_load_dwordx4 a[188:191], v2, s[32:35], s70 offen offset:256 nt
    v_and_b32 v8, v42, v3
    v_and_b32 v9, v42, v4
    v_and_b32 v10, v42, v5
    v_and_b32 v11, v42, v6
    s_nop 1
    v_mfma_f32_16x16x32_bf16 v[64:67], v[8:11], a[156:159], v[64:67]
    s_add_u32 s70, s69, 13
    s_and_b32 s70, s70, 31
    s_mul_i32 s70, s70, 49152
    s_waitcnt vmcnt(7)
    s_cmp_ge_u32 s56, 2
    s_cbranch_scc1 L_w64
    s_waitcnt vmcnt(5)
    s_cmp_ge_u32 s56, 1
    s_cbranch_scc1 L_w64
    s_waitcnt vmcnt(4)
L_w64:
    buffer_load_dwordx4 a[192:195], v2, s[32:35], s70 offen offset:0 nt
    v_mfma_f32_16x16x32_bf16 v[68:71], v[8:11], a[160:163], v[68:71]
    s_waitcnt vmcnt(7)
    s_cmp_ge_u32 s56, 2
    s_cbranch_scc1 L_w65
    s_waitcnt vmcnt(5)
    s_cmp_ge_u32 s56, 1
    s_cbranch_scc1 L_w65
    s_waitcnt vmcnt(4)
L_w65:
    buffer_load_dwordx4 a[196:199], v2, s[32:35], s70 offen offset:128 nt
    ds_read_b32 v86, v14 offset:16944
    v_mfma_f32_16x16x32_bf16 v[72:75], v[8:11], a[164:167], v[72:75]
    s_waitcnt vmcnt(7)
    s_cmp_ge_u32 s56, 2
    s_cbranch_scc1 L_w66
    s_waitcnt vmcnt(5)
    s_cmp_ge_u32 s56, 1
    s_cbranch_scc1 L_w66
    s_waitcnt vmcnt(4)
L_w66:
    buffer_load_dwordx4 a[200:203], v2, s[32:35], s70 offen offset:256 nt
    s_waitcnt lgkmcnt(0)
    v_readfirstlane_b32 s57, v86
    s_mov_b32 s56, 0
    s_cmp_ge_i32 s57, 31
    s_addc_u32 s56, s56, 0
    s_cmp_ge_i32 s57, 51
    s_addc_u32 s56, s56, 0
    v_and_b32 v8, v43, v3
    v_and_b32 v9, v43, v4
    v_and_b32 v10, v43, v5
    v_and_b32 v11, v43, v6
    s_nop 1
    v_mfma_f32_16x16x32_bf16 v[64:67], v[8:11], a[168:171], v[64:67]
    s_add_u32 s70, s69, 14
    s_and_b32 s70, s70, 31
    s_mul_i32 s70, s70, 49152
    s_waitcnt vmcnt(7)
    s_cmp_ge_u32 s56, 2
    s_cbranch_scc1 L_w67
    s_waitcnt vmcnt(5)
    s_cmp_ge_u32 s56, 1
    s_cbranch_scc1 L_w67
    s_waitcnt vmcnt(4)
L_w67:
    buffer_load_dwordx4 a[204:207], v2, s[32:35], s70 offen offset:0 nt
    v_mfma_f32_16x16x32_bf16 v[68:71], v[8:11], a[172:175], v[68:71]
    s_waitcnt vmcnt(7)
    s_cmp_ge_u32 s56, 2
    s_cbranch_scc1 L_w68
    s_waitcnt vmcnt(5)
    s_cmp_ge_u32 s56, 1
    s_cbranch_scc1 L_w68
    s_waitcnt vmcnt(4)
L_w68:
    buffer_load_dwordx4 a[208:211], v2, s[32:35], s70 offen offset:128 nt
    v_mfma_f32_16x16x32_bf16 v[72:75], v[8:11], a[176:179], v[72:75]
    s_waitcnt vmcnt(7)
    s_cmp_ge_u32 s56, 2
    s_cbranch_scc1 L_w69
    s_waitcnt vmcnt(5)
    s_cmp_ge_u32 s56, 1
    s_cbranch_scc1 L_w69
    s_waitcnt vmcnt(4)
L_w69:
    buffer_load_dwordx4 a[212:215], v2, s[32:35], s70 offen offset:256 nt
    v_and_b32 v8, v44, v3
    v_and_b32 v9, v44, v4
    v_and_b32 v10, v44, v5
    v_and_b32 v11, v44, v6
    s_nop 1
    v_mfma_f32_16x16x32_bf16 v[64:67], v[8:11], a[180:183], v[64:67]
    s_add_u32 s70, s69, 15
    s_and_b32 s70, s70, 31
    s_mul_i32 s70, s70, 49152
    s_waitcnt vmcnt(7)
    s_cmp_ge_u32 s56, 2
    s_cbranch_scc1 L_w70
    s_waitcnt vmcnt(5)
    s_cmp_ge_u32 s56, 1
    s_cbranch_scc1 L_w70
    s_waitcnt vmcnt(4)
L_w70:
    buffer_load_dwordx4 a[216:219], v2, s[32:35], s70 offen offset:0 nt
    v_mfma_f32_16x16x32_bf16 v[68:71], v[8:11], a[184:187], v[68:71]
    s_waitcnt vmcnt(7)
    s_cmp_ge_u32 s56, 2
    s_cbranch_scc1 L_w71
    s_waitcnt vmcnt(5)
    s_cmp_ge_u32 s56, 1
    s_cbranch_scc1 L_w71
    s_waitcnt vmcnt(4)
L_w71:
    buffer_load_dwordx4 a[220:223], v2, s[32:35], s70 offen offset:128 nt
    v_mfma_f32_16x16x32_bf16 v[72:75], v[8:11], a[188:191], v[72:75]
    s_waitcnt vmcnt(7)
    s_cmp_ge_u32 s56, 2
    s_cbranch_scc1 L_w72
    s_waitcnt vmcnt(5)
    s_cmp_ge_u32 s56, 1
    s_cbranch_scc1 L_w72
    s_waitcnt vmcnt(4)
L_w72:
    buffer_load_dwordx4 a[224:227], v2, s[32:35], s70 offen offset:256 nt
    v_and_b32 v8, v45, v3
    v_and_b32 v9, v45, v4
    v_and_b32 v10, v45, v5
    v_and_b32 v11, v45, v6
    s_nop 1
    v_mfma_f32_16x16x32_bf16 v[64:67], v[8:11], a[192:195], v[64:67]
    s_add_u32 s70, s69, 16
    s_and_b32 s70, s70, 31
    s_mul_i32 s70, s70, 49152
    s_waitcnt vmcnt(7)
    s_cmp_ge_u32 s56, 2
    s_cbranch_scc1 L_w73
    s_waitcnt vmcnt(5)
    s_cmp_ge_u32 s56, 1
    s_cbranch_scc1 L_w73
    s_waitcnt vmcnt(4)
L_w73:
    buffer_load_dwordx4 a[228:231], v2, s[32:35], s70 offen offset:0 nt
    v_mfma_f32_16x16x32_bf16 v[68:71], v[8:11], a[196:199], v[68:71]
    s_waitcnt vmcnt(7)
    s_cmp_ge_u32 s56, 2
    s_cbranch_scc1 L_w74
    s_waitcnt vmcnt(5)
    s_cmp_ge_u32 s56, 1
    s_cbranch_scc1 L_w74
    s_waitcnt vmcnt(4)
L_w74:
    buffer_load_dwordx4 a[232:235], v2, s[32:35], s70 offen offset:128 nt
    v_mfma_f32_16x16x32_bf16 v[72:75], v[8:11], a[200:203], v[72:75]
    s_waitcnt vmcnt(7)
    s_cmp_ge_u32 s56, 2
    s_cbranch_scc1 L_w75
    s_waitcnt vmcnt(5)
    s_cmp_ge_u32 s56, 1
    s_cbranch_scc1 L_w75
    s_waitcnt vmcnt(4)
L_w75:
    buffer_load_dwordx4 a[236:239], v2, s[32:35], s70 offen offset:256 nt
    v_and_b32 v8, v46, v3
    v_and_b32 v9, v46, v4
    v_and_b32 v10, v46, v5
    v_and_b32 v11, v46, v6
    s_nop 1
    v_mfma_f32_16x16x32_bf16 v[64:67], v[8:11], a[204:207], v[64:67]
    s_add_u32 s70, s69, 17
    s_and_b32 s70, s70, 31
    s_mul_i32 s70, s70, 49152
    s_waitcnt vmcnt(7)
    s_cmp_ge_u32 s56, 2
    s_cbranch_scc1 L_w76
    s_waitcnt vmcnt(5)
    s_cmp_ge_u32 s56, 1
    s_cbranch_scc1 L_w76
    s_waitcnt vmcnt(4)
L_w76:
    buffer_load_dwordx4 a[240:243], v2, s[32:35], s70 offen offset:0 nt
    v_mfma_f32_16x16x32_bf16 v[68:71], v[8:11], a[208:211], v[68:71]
    s_waitcnt vmcnt(7)
    s_cmp_ge_u32 s56, 2
    s_cbranch_scc1 L_w77
    s_waitcnt vmcnt(5)
    s_cmp_ge_u32 s56, 1
    s_cbranch_scc1 L_w77
    s_waitcnt vmcnt(4)
L_w77:
    buffer_load_dwordx4 a[244:247], v2, s[32:35], s70 offen offset:128 nt
    v_mfma_f32_16x16x32_bf16 v[72:75], v[8:11], a[212:215], v[72:75]
    s_waitcnt vmcnt(7)
    s_cmp_ge_u32 s56, 2
    s_cbranch_scc1 L_w78
    s_waitcnt vmcnt(5)
    s_cmp_ge_u32 s56, 1
    s_cbranch_scc1 L_w78
    s_waitcnt vmcnt(4)
L_w78:
    buffer_load_dwordx4 a[248:251], v2, s[32:35], s70 offen offset:256 nt
    v_and_b32 v8, v47, v3
    v_and_b32 v9, v47, v4
    v_and_b32 v10, v47, v5
    v_and_b32 v11, v47, v6
    s_nop 1
    v_mfma_f32_16x16x32_bf16 v[64:67], v[8:11], a[216:219], v[64:67]
    s_add_u32 s70, s69, 18
    s_and_b32 s70, s70, 31
    s_mul_i32 s70, s70, 49152
    s_waitcnt vmcnt(7)
    s_cmp_ge_u32 s56, 2
    s_cbranch_scc1 L_w79
    s_waitcnt vmcnt(5)
    s_cmp_ge_u32 s56, 1
    s_cbranch_scc1 L_w79
    s_waitcnt vmcnt(4)
L_w79:
    buffer_load_dwordx4 a[36:39], v2, s[32:35], s70 offen offset:0 nt
    v_mfma_f32_16x16x32_bf16 v[68:71], v[8:11], a[220:223], v[68:71]
    s_waitcnt vmcnt(7)
    s_cmp_ge_u32 s56, 2
    s_cbranch_scc1 L_w80
    s_waitcnt vmcnt(5)
    s_cmp_ge_u32 s56, 1
    s_cbranch_scc1 L_w80
    s_waitcnt vmcnt(4)
L_w80:
    buffer_load_dwordx4 a[40:43], v2, s[32:35], s70 offen offset:128 nt
    v_mfma_f32_16x16x32_bf16 v[72:75], v[8:11], a[224:227], v[72:75]
    s_waitcnt vmcnt(7)
    s_cmp_ge_u32 s56, 2
    s_cbranch_scc1 L_w81
    s_waitcnt vmcnt(5)
    s_cmp_ge_u32 s56, 1
    s_cbranch_scc1 L_w81
    s_waitcnt vmcnt(4)
L_w81:
    buffer_load_dwordx4 a[44:47], v2, s[32:35], s70 offen offset:256 nt
    v_and_b32 v8, v48, v3
    v_and_b32 v9, v48, v4
    v_and_b32 v10, v48, v5
    v_and_b32 v11, v48, v6
    s_nop 1
    v_mfma_f32_16x16x32_bf16 v[64:67], v[8:11], a[228:231], v[64:67]
    s_add_u32 s70, s69, 19
    s_and_b32 s70, s70, 31
    s_mul_i32 s70, s70, 49152
    s_waitcnt vmcnt(7)
    buffer_load_dwordx4 a[48:51], v2, s[32:35], s70 offen offset:0 nt
    v_mfma_f32_16x16x32_bf16 v[68:71], v[8:11], a[232:235], v[68:71]
    s_waitcnt vmcnt(7)
    buffer_load_dwordx4 a[52:55], v2, s[32:35], s70 offen offset:128 nt
    v_mfma_f32_16x16x32_bf16 v[72:75], v[8:11], a[236:239], v[72:75]
    s_waitcnt vmcnt(7)
    buffer_load_dwordx4 a[56:59], v2, s[32:35], s70 offen offset:256 nt
    v_and_b32 v8, v49, v3
    v_and_b32 v9, v49, v4
    v_and_b32 v10, v49, v5
    v_and_b32 v11, v49, v6
    s_nop 1
    v_mfma_f32_16x16x32_bf16 v[64:67], v[8:11], a[240:243], v[64:67]
    s_add_u32 s70, s69, 20
    s_and_b32 s70, s70, 31
    s_mul_i32 s70, s70, 49152
    s_waitcnt vmcnt(7)
    buffer_load_dwordx4 a[60:63], v2, s[32:35], s70 offen offset:0 nt
    v_mfma_f32_16x16x32_bf16 v[68:71], v[8:11], a[244:247], v[68:71]
    s_waitcnt vmcnt(7)
    buffer_load_dwordx4 a[64:67], v2, s[32:35], s70 offen offset:128 nt
    v_mfma_f32_16x16x32_bf16 v[72:75], v[8:11], a[248:251], v[72:75]
    s_waitcnt vmcnt(7)
    buffer_load_dwordx4 a[68:71], v2, s[32:35], s70 offen offset:256 nt
    v_and_b32 v8, v50, v3
    v_and_b32 v9, v50, v4
    v_and_b32 v10, v50, v5
    v_and_b32 v11, v50, v6
    s_nop 1
    v_mfma_f32_16x16x32_bf16 v[64:67], v[8:11], a[36:39], v[64:67]
    s_add_u32 s70, s69, 21
    s_and_b32 s70, s70, 31
    s_mul_i32 s70, s70, 49152
    s_waitcnt vmcnt(7)
    buffer_load_dwordx4 a[72:75], v2, s[32:35], s70 offen offset:0 nt
    v_mfma_f32_16x16x32_bf16 v[68:71], v[8:11], a[40:43], v[68:71]
    s_waitcnt vmcnt(7)
    buffer_load_dwordx4 a[76:79], v2, s[32:35], s70 offen offset:128 nt
    v_mfma_f32_16x16x32_bf16 v[72:75], v[8:11], a[44:47], v[72:75]
    s_waitcnt vmcnt(7)
    buffer_load_dwordx4 a[80:83], v2, s[32:35], s70 offen offset:256 nt
    v_and_b32 v8, v51, v3
    v_and_b32 v9, v51, v4
    v_and_b32 v10, v51, v5
    v_and_b32 v11, v51, v6
    s_nop 1
    v_mfma_f32_16x16x32_bf16 v[64:67], v[8:11], a[48:51], v[64:67]
    s_add_u32 s70, s69, 22
    s_and_b32 s70, s70, 31
    s_mul_i32 s70, s70, 49152
    s_waitcnt vmcnt(7)
    buffer_load_dwordx4 a[84:87], v2, s[32:35], s70 offen offset:0 nt
    v_mfma_f32_16x16x32_bf16 v[68:71], v[8:11], a[52:55], v[68:71]
    s_waitcnt vmcnt(7)
    buffer_load_dwordx4 a[88:91], v2, s[32:35], s70 offen offset:128 nt
    v_mfma_f32_16x16x32_bf16 v[72:75], v[8:11], a[56:59], v[72:75]
    s_waitcnt vmcnt(7)
    buffer_load_dwordx4 a[92:95], v2, s[32:35], s70 offen offset:256 nt
    v_and_b32 v8, v52, v3
    v_and_b32 v9, v52, v4
    v_and_b32 v10, v52, v5
    v_and_b32 v11, v52, v6
    s_nop 1
    v_mfma_f32_16x16x32_bf16 v[64:67], v[8:11], a[60:63], v[64:67]
    s_add_u32 s70, s69, 23
    s_and_b32 s70, s70, 31
    s_mul_i32 s70, s70, 49152
    s_waitcnt vmcnt(7)
    buffer_load_dwordx4 a[96:99], v2, s[32:35], s70 offen offset:0 nt
    v_mfma_f32_16x16x32_bf16 v[68:71], v[8:11], a[64:67], v[68:71]
    s_waitcnt vmcnt(7)
    buffer_load_dwordx4 a[100:103], v2, s[32:35], s70 offen offset:128 nt
    v_mfma_f32_16x16x32_bf16 v[72:75], v[8:11], a[68:71], v[72:75]
    s_waitcnt vmcnt(7)
    buffer_load_dwordx4 a[104:107], v2, s[32:35], s70 offen offset:256 nt
    v_and_b32 v8, v53, v3
    v_and_b32 v9, v53, v4
    v_and_b32 v10, v53, v5
    v_and_b32 v11, v53, v6
    s_nop 1
    v_mfma_f32_16x16x32_bf16 v[64:67], v[8:11], a[72:75], v[64:67]
    s_add_u32 s70, s69, 24
    s_and_b32 s70, s70, 31
    s_mul_i32 s70, s70, 49152
    s_waitcnt vmcnt(7)
    buffer_load_dwordx4 a[108:111], v2, s[32:35], s70 offen offset:0 nt
    v_mfma_f32_16x16x32_bf16 v[68:71], v[8:11], a[76:79], v[68:71]
    s_waitcnt vmcnt(7)
    buffer_load_dwordx4 a[112:115], v2, s[32:35], s70 offen offset:128 nt
    v_mfma_f32_16x16x32_bf16 v[72:75], v[8:11], a[80:83], v[72:75]
    s_waitcnt vmcnt(7)
    buffer_load_dwordx4 a[116:119], v2, s[32:35], s70 offen offset:256 nt
    v_and_b32 v8, v54, v3
    v_and_b32 v9, v54, v4
    v_and_b32 v10, v54, v5
    v_and_b32 v11, v54, v6
    s_nop 1
    v_mfma_f32_16x16x32_bf16 v[64:67], v[8:11], a[84:87], v[64:67]
    s_add_u32 s70, s69, 25
    s_and_b32 s70, s70, 31
    s_mul_i32 s70, s70, 49152
    s_waitcnt vmcnt(7)
    buffer_load_dwordx4 a[120:123], v2, s[32:35], s70 offen offset:0 nt
    v_mfma_f32_16x16x32_bf16 v[68:71], v[8:11], a[88:91], v[68:71]
    s_waitcnt vmcnt(7)
    buffer_load_dwordx4 a[124:127], v2, s[32:35], s70 offen offset:128 nt
    v_mfma_f32_16x16x32_bf16 v[72:75], v[8:11], a[92:95], v[72:75]
    s_waitcnt vmcnt(7)
    buffer_load_dwordx4 a[128:131], v2, s[32:35], s70 offen offset:256 nt
    v_and_b32 v8, v55, v3
    v_and_b32 v9, v55, v4
    v_and_b32 v10, v55, v5
    v_and_b32 v11, v55, v6
    s_nop 1
    v_mfma_f32_16x16x32_bf16 v[64:67], v[8:11], a[96:99], v[64:67]
    s_add_u32 s70, s69, 26
    s_and_b32 s70, s70, 31
    s_mul_i32 s70, s70, 49152
    s_waitcnt vmcnt(7)
    buffer_load_dwordx4 a[132:135], v2, s[32:35], s70 offen offset:0 nt
    s_lshr_b32 s77, s2, 3
    s_lshr_b32 s71, s2, 5
    s_add_u32 s77, s77, s71
    s_and_b32 s77, s77, 3
    s_mul_i32 s71, s77, 4352
    s_add_u32 s71, s71, 851968
    v_cmp_eq_u32 vcc, 0, v0
    v_mov_b32 v84, 4
    v_mov_b32 v85, s71
    v_cndmask_b32 v85, v16, v85, vcc
    buffer_atomic_add v84, v85, s[44:47], 0 offen sc0 sc1
    v_mfma_f32_16x16x32_bf16 v[68:71], v[8:11], a[100:103], v[68:71]
    s_waitcnt vmcnt(7)
    buffer_load_dwordx4 a[136:139], v2, s[32:35], s70 offen offset:128 nt
    v_mfma_f32_16x16x32_bf16 v[72:75], v[8:11], a[104:107], v[72:75]
    v_and_b32 v8, v56, v3
    v_and_b32 v9, v56, v4
    v_and_b32 v10, v56, v5
    v_and_b32 v11, v56, v6
    s_nop 1
    v_mfma_f32_16x16x32_bf16 v[64:67], v[8:11], a[108:111], v[64:67]
    s_waitcnt vmcnt(7)
    buffer_load_dwordx4 a[140:143], v2, s[32:35], s70 offen offset:256 nt
    v_mfma_f32_16x16x32_bf16 v[68:71], v[8:11], a[112:115], v[68:71]
    s_add_u32 s70, s69, 27
    s_and_b32 s70, s70, 31
    s_mul_i32 s70, s70, 49152
    s_waitcnt vmcnt(7)
    buffer_load_dwordx4 a[144:147], v2, s[32:35], s70 offen offset:0 nt
    v_mfma_f32_16x16x32_bf16 v[72:75], v[8:11], a[116:119], v[72:75]
    s_waitcnt vmcnt(7)
    buffer_load_dwordx4 a[148:151], v2, s[32:35], s70 offen offset:128 nt
    v_and_b32 v8, v57, v3
    v_and_b32 v9, v57, v4
    v_and_b32 v10, v57, v5
    v_and_b32 v11, v57, v6
    s_nop 1
    v_mfma_f32_16x16x32_bf16 v[64:67], v[8:11], a[120:123], v[64:67]
    s_waitcnt vmcnt(7)
    buffer_load_dwordx4 a[152:155], v2, s[32:35], s70 offen offset:256 nt
    v_mfma_f32_16x16x32_bf16 v[68:71], v[8:11], a[124:127], v[68:71]
    s_add_u32 s70, s69, 28
    s_and_b32 s70, s70, 31
    s_mul_i32 s70, s70, 49152
    s_waitcnt vmcnt(7)
    buffer_load_dwordx4 a[156:159], v2, s[32:35], s70 offen offset:0 nt
    v_mfma_f32_16x16x32_bf16 v[72:75], v[8:11], a[128:131], v[72:75]
    s_waitcnt vmcnt(7)
    buffer_load_dwordx4 a[160:163], v2, s[32:35], s70 offen offset:128 nt
    v_and_b32 v8, v58, v3
    v_and_b32 v9, v58, v4
    v_and_b32 v10, v58, v5
    v_and_b32 v11, v58, v6
    s_nop 1
    v_mfma_f32_16x16x32_bf16 v[64:67], v[8:11], a[132:135], v[64:67]
    s_waitcnt vmcnt(7)
    buffer_load_dwordx4 a[164:167], v2, s[32:35], s70 offen offset:256 nt
    v_add_f32 v78, v78, v79
    s_nop 1
    v_add_f32_dpp v78, v78, v78 row_ror:8 row_mask:0xf bank_mask:0xf
    v_mov_b32 v15, v78
    s_nop 1
    v_permlane16_swap_b32 v78, v15
    v_add_f32 v78, v78, v15
    v_mov_b32 v15, v78
    s_nop 1
    v_permlane32_swap_b32 v78, v15
    v_add_f32 v78, v78, v15
    s_lshl_b32 s71, s3, 2
    v_mov_b32 v7, s71
    s_mov_b64 exec, 1
    ds_write_b32 v7, v77 offset:16896
    ds_write_b32 v7, v78 offset:16912
    ds_write_b32 v7, v84 offset:16928
    s_mov_b64 exec, -1
    s_add_u32 s70, s69, 29
    s_and_b32 s70, s70, 31
    s_mul_i32 s70, s70, 49152
    buffer_load_dwordx4 a[168:171], v2, s[32:35], s70 offen offset:0 nt
    buffer_load_dwordx4 a[172:175], v2, s[32:35], s70 offen offset:128 nt
    s_waitcnt lgkmcnt(0)
    s_barrier
    ds_read_b128 v[80:83], v14 offset:16896
    ds_read_b128 v[28:31], v14 offset:16912
    ds_read_b32 v84, v14 offset:16928
    s_lshl_b32 s71, s66, 6
    s_lshl_b32 s72, s67, 5
    s_add_u32 s71, s71, s72
    s_lshl_b32 s72, s65, 2
    s_add_u32 s71, s71, s72
    s_add_u32 s71, s71, 458752
    v_lshl_add_u32 v85, v0, 4, s71
    v_cmp_gt_u32 vcc, 2, v0
    s_waitcnt lgkmcnt(0)
    v_max3_f32 v7, v80, v81, v82
    v_cndmask_b32 v85, v16, v85, vcc
    v_max_f32 v7, v7, v83
    v_cmp_eq_u32 vcc, 0, v0
    v_sub_f32 v80, v80, v7
    v_sub_f32 v81, v81, v7
    v_sub_f32 v82, v82, v7
    v_sub_f32 v83, v83, v7
    v_exp_f32 v80, v80
    v_exp_f32 v81, v81
    v_exp_f32 v82, v82
    v_exp_f32 v83, v83
    v_mul_f32 v15, v80, v28
    v_fmac_f32 v15, v81, v29
    v_fmac_f32 v15, v82, v30
    v_fmac_f32 v15, v83, v31
    v_cndmask_b32 v15, v15, v7, vcc
    v_min_u32 v15, -2, v15
    buffer_store_dword v15, v85, s[44:47], 0 offen sc1
    v_readfirstlane_b32 s79, v84
    s_add_u32 s77, s77, 1
    s_add_u32 s79, s79, s77
    s_cmp_ge_u32 s79, 80
    s_cbranch_scc1 L_rm1
    s_and_b32 s71, s79, -8
    s_cmp_lt_u32 s79, 40
    s_cselect_b32 s72, 8, -80
    s_add_u32 s79, s79, s71
    s_add_u32 s79, s79, s72
    s_branch L_rm3
L_rm1:
    s_cmp_ge_u32 s79, 86
    s_cbranch_scc1 L_rm2
    s_sub_u32 s71, s79, 80
    s_and_b32 s71, s71, -2
    s_mul_i32 s71, s71, 7
    s_add_u32 s79, s79, s71
    s_add_u32 s79, s79, 46
    s_branch L_rm3
L_rm2:
    s_cmp_lt_u32 s79, 148
    s_cselect_b32 s72, 20, -42
    s_cmp_lt_u32 s79, 106
    s_cselect_b32 s72, 0, s72
    s_cmp_ge_u32 s79, 168
    s_cselect_b32 s72, 0, s72
    s_add_u32 s79, s79, s72
    s_sub_u32 s79, s79, 6
    s_mov_b32 s71, s79
    s_cmp_ge_u32 s71, 126
    s_cselect_b32 s72, 2, 0
    s_add_u32 s79, s79, s72
    s_cmp_ge_u32 s71, 140
    s_cselect_b32 s72, 2, 0
    s_add_u32 s79, s79, s72
    s_cmp_ge_u32 s71, 154
    s_cselect_b32 s72, 2, 0
    s_add_u32 s79, s79, s72
    s_cmp_ge_u32 s79, 120
    s_cbranch_scc1 L_rm3
    s_sub_u32 s71, s79, 80
    s_and_b32 s71, s71, -4
    s_cmp_lt_u32 s79, 100
    s_cselect_b32 s72, 4, -40
    s_add_u32 s79, s79, s71
    s_add_u32 s79, s79, s72
L_rm3:
    v_lshrrev_b32 v24, 4, v1
    v_and_b32 v25, 3, v1
    s_sub_u32 s76, s79, 0
    s_cmp_lt_u32 s76, 80
    s_cbranch_scc1 L_roleA
    s_sub_u32 s76, s79, 120
    s_cmp_lt_u32 s76, 48
    s_cbranch_scc1 L_roleB
    s_sub_u32 s76, s79, 80
    s_cmp_lt_u32 s76, 40
    s_cbranch_scc1 L_roleC
    s_waitcnt vmcnt(8)
    buffer_load_dwordx4 a[176:179], v2, s[32:35], s70 offen offset:256 nt
    v_mfma_f32_16x16x32_bf16 v[68:71], v[8:11], a[136:139], v[68:71]
    v_mfma_f32_16x16x32_bf16 v[72:75], v[8:11], a[140:143], v[72:75]
    v_and_b32 v8, v59, v3
    v_and_b32 v9, v59, v4
    v_and_b32 v10, v59, v5
    v_and_b32 v11, v59, v6
    s_nop 1
    v_mfma_f32_16x16x32_bf16 v[64:67], v[8:11], a[144:147], v[64:67]
    s_add_u32 s70, s69, 30
    s_and_b32 s70, s70, 31
    s_mul_i32 s70, s70, 49152
    s_waitcnt vmcnt(8)
    buffer_load_dwordx4 a[180:183], v2, s[32:35], s70 offen offset:0 nt
    v_mfma_f32_16x16x32_bf16 v[68:71], v[8:11], a[148:151], v[68:71]
    s_waitcnt vmcnt(8)
    buffer_load_dwordx4 a[184:187], v2, s[32:35], s70 offen offset:128 nt
    v_mfma_f32_16x16x32_bf16 v[72:75], v[8:11], a[152:155], v[72:75]
    s_waitcnt vmcnt(8)
    buffer_load_dwordx4 a[188:191], v2, s[32:35], s70 offen offset:256 nt
    v_and_b32 v8, v60, v3
    v_and_b32 v9, v60, v4
    v_and_b32 v10, v60, v5
    v_and_b32 v11, v60, v6
    s_nop 1
    v_mfma_f32_16x16x32_bf16 v[64:67], v[8:11], a[156:159], v[64:67]
    s_add_u32 s70, s69, 31
    s_and_b32 s70, s70, 31
    s_mul_i32 s70, s70, 49152
    s_waitcnt vmcnt(8)
    buffer_load_dwordx4 a[192:195], v2, s[32:35], s70 offen offset:0 nt
    v_mfma_f32_16x16x32_bf16 v[68:71], v[8:11], a[160:163], v[68:71]
    s_waitcnt vmcnt(8)
    buffer_load_dwordx4 a[196:199], v2, s[32:35], s70 offen offset:128 nt
    v_mfma_f32_16x16x32_bf16 v[72:75], v[8:11], a[164:167], v[72:75]
    s_waitcnt vmcnt(8)
    buffer_load_dwordx4 a[200:203], v2, s[32:35], s70 offen offset:256 nt
    v_and_b32 v8, v61, v3
    v_and_b32 v9, v61, v4
    v_and_b32 v10, v61, v5
    v_and_b32 v11, v61, v6
    s_nop 1
    v_mfma_f32_16x16x32_bf16 v[64:67], v[8:11], a[168:171], v[64:67]
    s_waitcnt vmcnt(8)
    v_mfma_f32_16x16x32_bf16 v[68:71], v[8:11], a[172:175], v[68:71]
    s_waitcnt vmcnt(6)
    v_mfma_f32_16x16x32_bf16 v[72:75], v[8:11], a[176:179], v[72:75]
    v_and_b32 v8, v62, v3
    v_and_b32 v9, v62, v4
    v_and_b32 v10, v62, v5
    v_and_b32 v11, v62, v6
    s_waitcnt vmcnt(5)
    s_nop 0
    v_mfma_f32_16x16x32_bf16 v[64:67], v[8:11], a[180:183], v[64:67]
    s_waitcnt vmcnt(4)
    v_mfma_f32_16x16x32_bf16 v[68:71], v[8:11], a[184:187], v[68:71]
    s_waitcnt vmcnt(3)
    v_mfma_f32_16x16x32_bf16 v[72:75], v[8:11], a[188:191], v[72:75]
    v_and_b32 v8, v63, v3
    v_and_b32 v9, v63, v4
    v_and_b32 v10, v63, v5
    v_and_b32 v11, v63, v6
    s_waitcnt vmcnt(2)
    s_nop 0
    v_mfma_f32_16x16x32_bf16 v[64:67], v[8:11], a[192:195], v[64:67]
    s_waitcnt vmcnt(1)
    v_mfma_f32_16x16x32_bf16 v[68:71], v[8:11], a[196:199], v[68:71]
    s_waitcnt vmcnt(0)
    v_mfma_f32_16x16x32_bf16 v[72:75], v[8:11], a[200:203], v[72:75]
    s_mov_b32 exec_lo, 0xff00ff
    s_mov_b32 exec_hi, 0xff00ff00
    s_nop 1
    ds_write_b128 v19, v[64:67] offset:0
    s_nop 0
    ds_write_b128 v19, v[68:71] offset:256
    s_nop 0
    ds_write_b128 v19, v[72:75] offset:512
    s_mov_b64 exec, -1
    s_waitcnt lgkmcnt(0)
    s_barrier
    s_cmp_ge_u32 s3, 2
    s_cbranch_scc1 L_onoredN
    ds_read2st64_b64 v[32:35], v13 offset0:0 offset1:2
    ds_read2st64_b64 v[36:39], v13 offset0:4 offset1:6
    ds_read2st64_b64 v[40:43], v13 offset0:8 offset1:10
    ds_read2st64_b64 v[44:47], v13 offset0:12 offset1:14
    s_waitcnt lgkmcnt(2)
    v_pk_add_f32 v[32:33], v[32:33], v[34:35]
    v_pk_add_f32 v[36:37], v[36:37], v[38:39]
    v_pk_mul_f32 v[32:33], v[32:33], v[80:81] op_sel_hi:[1,0]
    v_pk_fma_f32 v[32:33], v[36:37], v[80:81], v[32:33] op_sel:[0,1,0] op_sel_hi:[1,1,1]
    s_waitcnt lgkmcnt(0)
    v_pk_add_f32 v[40:41], v[40:41], v[42:43]
    v_pk_add_f32 v[44:45], v[44:45], v[46:47]
    v_pk_fma_f32 v[32:33], v[40:41], v[82:83], v[32:33] op_sel_hi:[1,0,1]
    v_pk_fma_f32 v[32:33], v[44:45], v[82:83], v[32:33] op_sel:[0,1,0] op_sel_hi:[1,1,1]
    v_cvt_pk_bf16_f32 v32, v32, v33
    v_min_u32 v32, -2, v32
    buffer_store_dword v32, v12, s[44:47], s39 offen sc1
    buffer_store_dword v32, v12, s[44:47], s38 offen sc1
L_onoredN:
    s_branch L_end
L_roleA:
    s_and_b32 s77, s76, 7
    s_lshr_b32 s78, s76, 3
    s_mov_b32 s52, s12
    s_mov_b32 s53, s13
    s_mov_b32 s54, 7864320
    s_mov_b32 s55, 0x20000
    s_lshl_b32 s66, s77, 2
    s_add_u32 s66, s66, s3
    v_lshrrev_b32 v20, 3, v1
    v_mul_u32_u24 v20, 1280, v20
    v_and_b32 v21, 1, v24
    v_lshlrev_b32 v21, 1, v21
    v_and_b32 v22, 7, v1
    v_xor_b32 v21, v21, v22
    v_lshl_add_u32 v26, v21, 4, v20
    s_mul_i32 s64, s66, 245760
    s_lshl_b32 s71, s78, 7
    s_add_u32 s64, s64, s71
    s_mul_i32 s72, s3, 26112
    s_add_u32 s72, s72, 23296
    s_mov_b32 s73, s72
    s_waitcnt vmcnt(8)
    buffer_load_dwordx4 a[176:179], v2, s[32:35], s70 offen offset:256 nt
    v_mfma_f32_16x16x32_bf16 v[68:71], v[8:11], a[136:139], v[68:71]
    v_mfma_f32_16x16x32_bf16 v[72:75], v[8:11], a[140:143], v[72:75]
    v_and_b32 v8, v59, v3
    v_and_b32 v9, v59, v4
    v_and_b32 v10, v59, v5
    v_and_b32 v11, v59, v6
    s_nop 1
    v_mfma_f32_16x16x32_bf16 v[64:67], v[8:11], a[144:147], v[64:67]
    s_add_u32 s70, s69, 30
    s_and_b32 s70, s70, 31
    s_mul_i32 s70, s70, 49152
    s_waitcnt vmcnt(8)
    buffer_load_dwordx4 a[180:183], v2, s[32:35], s70 offen offset:0 nt
    v_mfma_f32_16x16x32_bf16 v[68:71], v[8:11], a[148:151], v[68:71]
    s_waitcnt vmcnt(8)
    buffer_load_dwordx4 a[184:187], v2, s[32:35], s70 offen offset:128 nt
    v_mfma_f32_16x16x32_bf16 v[72:75], v[8:11], a[152:155], v[72:75]
    s_waitcnt vmcnt(8)
    buffer_load_dwordx4 a[188:191], v2, s[32:35], s70 offen offset:256 nt
    v_and_b32 v8, v60, v3
    v_and_b32 v9, v60, v4
    v_and_b32 v10, v60, v5
    v_and_b32 v11, v60, v6
    s_nop 1
    v_mfma_f32_16x16x32_bf16 v[64:67], v[8:11], a[156:159], v[64:67]
    s_add_u32 s70, s69, 31
    s_and_b32 s70, s70, 31
    s_mul_i32 s70, s70, 49152
    s_waitcnt vmcnt(8)
    buffer_load_dwordx4 a[192:195], v2, s[32:35], s70 offen offset:0 nt
    v_mfma_f32_16x16x32_bf16 v[68:71], v[8:11], a[160:163], v[68:71]
    s_waitcnt vmcnt(8)
    buffer_load_dwordx4 a[196:199], v2, s[32:35], s70 offen offset:128 nt
    v_mfma_f32_16x16x32_bf16 v[72:75], v[8:11], a[164:167], v[72:75]
    s_waitcnt vmcnt(8)
    buffer_load_dwordx4 a[200:203], v2, s[32:35], s70 offen offset:256 nt
    v_and_b32 v8, v61, v3
    v_and_b32 v9, v61, v4
    v_and_b32 v10, v61, v5
    v_and_b32 v11, v61, v6
    s_nop 1
    v_mfma_f32_16x16x32_bf16 v[64:67], v[8:11], a[168:171], v[64:67]
    s_waitcnt vmcnt(8)
    v_mfma_f32_16x16x32_bf16 v[68:71], v[8:11], a[172:175], v[68:71]
    s_mov_b32 m0, s73
    s_add_u32 s73, s73, 1088
    buffer_load_dwordx4 v26, s[52:55], s64 offen nt lds
    s_add_u32 s64, s64, 10240
    s_mov_b32 m0, s73
    s_add_u32 s73, s73, 1088
    buffer_load_dwordx4 v26, s[52:55], s64 offen nt lds
    s_add_u32 s64, s64, 10240
    s_waitcnt vmcnt(8)
    v_mfma_f32_16x16x32_bf16 v[72:75], v[8:11], a[176:179], v[72:75]
    s_mov_b32 m0, s73
    s_add_u32 s73, s73, 1088
    buffer_load_dwordx4 v26, s[52:55], s64 offen nt lds
    s_add_u32 s64, s64, 10240
    v_and_b32 v8, v62, v3
    v_and_b32 v9, v62, v4
    v_and_b32 v10, v62, v5
    v_and_b32 v11, v62, v6
    s_waitcnt vmcnt(8)
    s_nop 0
    v_mfma_f32_16x16x32_bf16 v[64:67], v[8:11], a[180:183], v[64:67]
    s_mov_b32 m0, s73
    s_add_u32 s73, s73, 1088
    buffer_load_dwordx4 v26, s[52:55], s64 offen nt lds
    s_add_u32 s64, s64, 10240
    s_waitcnt vmcnt(8)
    v_mfma_f32_16x16x32_bf16 v[68:71], v[8:11], a[184:187], v[68:71]
    s_mov_b32 m0, s73
    s_add_u32 s73, s73, 1088
    buffer_load_dwordx4 v26, s[52:55], s64 offen nt lds
    s_add_u32 s64, s64, 10240
    s_waitcnt vmcnt(8)
    v_mfma_f32_16x16x32_bf16 v[72:75], v[8:11], a[188:191], v[72:75]
    s_mov_b32 m0, s73
    s_add_u32 s73, s73, 1088
    buffer_load_dwordx4 v26, s[52:55], s64 offen nt lds
    s_add_u32 s64, s64, 10240
    v_and_b32 v8, v63, v3
    v_and_b32 v9, v63, v4
    v_and_b32 v10, v63, v5
    v_and_b32 v11, v63, v6
    s_waitcnt vmcnt(8)
    s_nop 0
    v_mfma_f32_16x16x32_bf16 v[64:67], v[8:11], a[192:195], v[64:67]
    s_mov_b32 m0, s73
    s_add_u32 s73, s73, 1088
    buffer_load_dwordx4 v26, s[52:55], s64 offen nt lds
    s_add_u32 s64, s64, 10240
    s_waitcnt vmcnt(8)
    v_mfma_f32_16x16x32_bf16 v[68:71], v[8:11], a[196:199], v[68:71]
    s_mov_b32 m0, s73
    s_add_u32 s73, s73, 1088
    buffer_load_dwordx4 v26, s[52:55], s64 offen nt lds
    s_add_u32 s64, s64, 10240
    s_waitcnt vmcnt(8)
    v_mfma_f32_16x16x32_bf16 v[72:75], v[8:11], a[200:203], v[72:75]
    s_mov_b32 m0, s73
    s_add_u32 s73, s73, 1088
    buffer_load_dwordx4 v26, s[52:55], s64 offen nt lds
    s_add_u32 s64, s64, 10240
    s_mov_b32 exec_lo, 0xff00ff
    s_mov_b32 exec_hi, 0xff00ff00
    ds_write_b128 v19, v[64:67] offset:0
    ds_write_b128 v19, v[68:71] offset:256
    ds_write_b128 v19, v[72:75] offset:512
    s_mov_b64 exec, -1
    s_waitcnt lgkmcnt(0)
    s_barrier
    s_cmp_ge_u32 s3, 2
    s_cbranch_scc1 L_onoredA
    ds_read2st64_b64 v[32:35], v13 offset0:0 offset1:2
    ds_read2st64_b64 v[36:39], v13 offset0:4 offset1:6
    ds_read2st64_b64 v[40:43], v13 offset0:8 offset1:10
    ds_read2st64_b64 v[44:47], v13 offset0:12 offset1:14
    s_waitcnt lgkmcnt(2)
    v_pk_add_f32 v[32:33], v[32:33], v[34:35]
    v_pk_add_f32 v[36:37], v[36:37], v[38:39]
    v_pk_mul_f32 v[32:33], v[32:33], v[80:81] op_sel_hi:[1,0]
    v_pk_fma_f32 v[32:33], v[36:37], v[80:81], v[32:33] op_sel:[0,1,0] op_sel_hi:[1,1,1]
    s_waitcnt lgkmcnt(0)
    v_pk_add_f32 v[40:41], v[40:41], v[42:43]
    v_pk_add_f32 v[44:45], v[44:45], v[46:47]
    v_pk_fma_f32 v[32:33], v[40:41], v[82:83], v[32:33] op_sel_hi:[1,0,1]
    v_pk_fma_f32 v[32:33], v[44:45], v[82:83], v[32:33] op_sel:[0,1,0] op_sel_hi:[1,1,1]
    v_cvt_pk_bf16_f32 v32, v32, v33
    v_min_u32 v32, -2, v32
    buffer_store_dword v32, v12, s[44:47], s39 offen sc1
    buffer_store_dword v32, v12, s[44:47], s38 offen sc1
L_onoredA:
    s_barrier
    s_mov_b32 m0, s73
    s_add_u32 s73, s73, 1088
    buffer_load_dwordx4 v26, s[52:55], s64 offen nt lds
    s_add_u32 s64, s64, 10240
    s_mov_b32 m0, s73
    s_add_u32 s73, s73, 1088
    buffer_load_dwordx4 v26, s[52:55], s64 offen nt lds
    s_add_u32 s64, s64, 10240
    s_mov_b32 m0, s73
    s_add_u32 s73, s73, 1088
    buffer_load_dwordx4 v26, s[52:55], s64 offen nt lds
    s_add_u32 s64, s64, 10240
    s_mov_b32 m0, s73
    s_add_u32 s73, s73, 1088
    buffer_load_dwordx4 v26, s[52:55], s64 offen nt lds
    s_add_u32 s64, s64, 10240
    s_mov_b32 m0, s73
    s_add_u32 s73, s73, 1088
    buffer_load_dwordx4 v26, s[52:55], s64 offen nt lds
    s_add_u32 s64, s64, 10240
    s_mov_b32 m0, s73
    s_add_u32 s73, s73, 1088
    buffer_load_dwordx4 v26, s[52:55], s64 offen nt lds
    s_add_u32 s64, s64, 10240
    s_mov_b32 m0, s73
    s_add_u32 s73, s73, 1088
    buffer_load_dwordx4 v26, s[52:55], s64 offen nt lds
    s_add_u32 s64, s64, 10240
    s_mov_b32 m0, s73
    s_add_u32 s73, s73, 1088
    buffer_load_dwordx4 v26, s[52:55], s64 offen nt lds
    s_add_u32 s64, s64, 10240
    s_mov_b32 m0, s73
    s_add_u32 s73, s73, 1088
    buffer_load_dwordx4 v26, s[52:55], s64 offen nt lds
    s_add_u32 s64, s64, 10240
    s_mov_b32 m0, s73
    s_add_u32 s73, s73, 1088
    buffer_load_dwordx4 v26, s[52:55], s64 offen nt lds
    s_add_u32 s64, s64, 10240
    s_mov_b32 m0, s73
    s_add_u32 s73, s73, 1088
    buffer_load_dwordx4 v26, s[52:55], s64 offen nt lds
    s_add_u32 s64, s64, 10240
    s_mov_b32 m0, s73
    s_add_u32 s73, s73, 1088
    buffer_load_dwordx4 v26, s[52:55], s64 offen nt lds
    s_add_u32 s64, s64, 10240
    s_mov_b32 m0, s73
    s_add_u32 s73, s73, 1088
    buffer_load_dwordx4 v26, s[52:55], s64 offen nt lds
    s_add_u32 s64, s64, 10240
    s_mov_b32 m0, s73
    s_add_u32 s73, s73, 1088
    buffer_load_dwordx4 v26, s[52:55], s64 offen nt lds
    s_add_u32 s64, s64, 10240
    s_mov_b32 m0, s73
    s_add_u32 s73, s73, 1088
    buffer_load_dwordx4 v26, s[52:55], s64 offen nt lds
    s_add_u32 s64, s64, 10240
    v_lshrrev_b32 v7, 4, v1
    v_bfe_u32 v8, v1, 2, 2
    v_and_b32 v9, 3, v1
    v_and_b32 v10, 15, v1
    s_cmp_eq_u32 s77, 0
    s_cselect_b32 s71, s71, 1073741824
    v_lshrrev_b32 v14, 5, v1
    v_and_b32 v15, 31, v1
    v_mul_u32_u24 v16, 1280, v14
    v_lshl_add_u32 v16, v15, 2, v16
    v_add_u32 v59, s71, v16
    s_lshl_b32 s71, s66, 6
    s_add_u32 s71, s71, 458752
    v_and_b32 v58, 1, v7
    v_lshl_add_u32 v58, v58, 5, s71
    s_lshr_b32 s74, s66, 1
    s_and_b32 s71, s66, 1
    s_lshl2_add_u32 s71, s74, s71
    s_lshl_b32 s71, s71, 12
    s_add_u32 s71, s71, 524288
    s_add_u32 s71, s71, s38
    v_and_b32 v57, 7, v1
    v_lshlrev_b32 v57, 6, v57
    v_lshl_add_u32 v57, v7, 4, v57
    v_add_u32 v57, s71, v57
    s_lshl_b32 s71, s78, 14
    s_lshl_b32 s74, s77, 7
    s_add_u32 s71, s71, s74
    s_add_u32 s71, s71, 527360
    v_and_b32 v15, 1, v7
    v_lshlrev_b32 v15, 12, v15
    v_lshl_add_u32 v15, v14, 6, v15
    v_lshl_add_u32 v15, v10, 2, v15
    v_add_u32 v16, s71, v15
    v_lshlrev_b32 v17, 3, v1
    v_add_u32 v17, 16960, v17
    s_lshl_b32 s71, s3, 9
    s_add_u32 s71, s71, 16960
    v_lshlrev_b32 v15, 8, v7
    v_lshl_add_u32 v15, v10, 2, v15
    v_add_u32 v15, s71, v15
    v_mul_u32_u24 v11, 1088, v7
    v_lshl_add_u32 v11, v8, 7, v11
    v_lshl_add_u32 v11, v9, 3, v11
    v_add_u32 v11, s72, v11
    v_lshrrev_b32 v12, 1, v8
    v_lshl_add_u32 v13, v12, 5, v11
    v_xor_b32 v12, 1, v12
    v_lshl_add_u32 v14, v12, 5, v11
    s_waitcnt vmcnt(20)
    ds_read_b64_tr_b16 v[64:65], v13 offset:0
    ds_read_b64_tr_b16 v[66:67], v13 offset:512
    ds_read_b64_tr_b16 v[68:69], v14 offset:0
    ds_read_b64_tr_b16 v[70:71], v14 offset:512
    ds_read_b64_tr_b16 v[72:73], v13 offset:64
    ds_read_b64_tr_b16 v[74:75], v13 offset:576
    ds_read_b64_tr_b16 v[76:77], v14 offset:64
    ds_read_b64_tr_b16 v[78:79], v14 offset:576
    s_waitcnt vmcnt(16)
    ds_read_b64_tr_b16 v[80:81], v13 offset:4352
    ds_read_b64_tr_b16 v[82:83], v13 offset:4864
    ds_read_b64_tr_b16 v[84:85], v14 offset:4352
    ds_read_b64_tr_b16 v[86:87], v14 offset:4864
    ds_read_b64_tr_b16 v[88:89], v13 offset:4416
    ds_read_b64_tr_b16 v[90:91], v13 offset:4928
    ds_read_b64_tr_b16 v[92:93], v14 offset:4416
    ds_read_b64_tr_b16 v[94:95], v14 offset:4928
    s_waitcnt vmcnt(12)
    ds_read_b64_tr_b16 v[96:97], v13 offset:8704
    ds_read_b64_tr_b16 v[98:99], v13 offset:9216
    ds_read_b64_tr_b16 v[100:101], v14 offset:8704
    ds_read_b64_tr_b16 v[102:103], v14 offset:9216
    ds_read_b64_tr_b16 v[104:105], v13 offset:8768
    ds_read_b64_tr_b16 v[106:107], v13 offset:9280
    ds_read_b64_tr_b16 v[108:109], v14 offset:8768
    ds_read_b64_tr_b16 v[110:111], v14 offset:9280
    s_waitcnt vmcnt(8)
    ds_read_b64_tr_b16 v[112:113], v13 offset:13056
    ds_read_b64_tr_b16 v[114:115], v13 offset:13568
    ds_read_b64_tr_b16 v[116:117], v14 offset:13056
    ds_read_b64_tr_b16 v[118:119], v14 offset:13568
    ds_read_b64_tr_b16 v[120:121], v13 offset:13120
    ds_read_b64_tr_b16 v[122:123], v13 offset:13632
    ds_read_b64_tr_b16 v[124:125], v14 offset:13120
    ds_read_b64_tr_b16 v[126:127], v14 offset:13632
    s_waitcnt vmcnt(4)
    buffer_load_dword v19, v59, s[40:43], 0 offen
    buffer_load_dwordx4 v[20:23], v58, s[44:47], 0 offen sc1
    buffer_load_dwordx4 v[24:27], v58, s[44:47], 0 offen offset:16 sc1
    s_mov_b32 exec_lo, 0xff00ff
    s_mov_b32 exec_hi, 0xff00ff
    buffer_load_dwordx4 v[32:35], v57, s[44:47], 0 offen offset:0 sc1
    buffer_load_dwordx4 v[36:39], v57, s[44:47], 0 offen offset:512 sc1
    buffer_load_dwordx4 v[40:43], v57, s[44:47], 0 offen offset:1024 sc1
    buffer_load_dwordx4 v[44:47], v57, s[44:47], 0 offen offset:1536 sc1
    buffer_load_dwordx4 v[48:51], v57, s[44:47], 0 offen offset:2048 sc1
    buffer_load_dwordx4 v[52:55], v57, s[44:47], 0 offen offset:2560 sc1
    s_mov_b64 exec, -1
    ds_read_b64_tr_b16 v[128:129], v13 offset:17408
    ds_read_b64_tr_b16 v[130:131], v13 offset:17920
    ds_read_b64_tr_b16 v[132:133], v14 offset:17408
    ds_read_b64_tr_b16 v[134:135], v14 offset:17920
    ds_read_b64_tr_b16 v[136:137], v13 offset:17472
    ds_read_b64_tr_b16 v[138:139], v13 offset:17984
    ds_read_b64_tr_b16 v[140:141], v14 offset:17472
    ds_read_b64_tr_b16 v[142:143], v14 offset:17984
    s_waitcnt vmcnt(9)
    ds_read_b64_tr_b16 v[144:145], v13 offset:21760
    ds_read_b64_tr_b16 v[146:147], v13 offset:22272
    ds_read_b64_tr_b16 v[148:149], v14 offset:21760
    ds_read_b64_tr_b16 v[150:151], v14 offset:22272
    ds_read_b64_tr_b16 v[152:153], v13 offset:21824
    ds_read_b64_tr_b16 v[154:155], v13 offset:22336
    ds_read_b64_tr_b16 v[156:157], v14 offset:21824
    ds_read_b64_tr_b16 v[158:159], v14 offset:22336
    s_mov_b32 s75, 0
    s_mov_b64 exec, -1
    s_waitcnt vmcnt(7)
    v_max3_u32 v11, v20, v21, v22
    v_max_u32 v11, v11, v23
    s_waitcnt vmcnt(6)
    v_max3_u32 v11, v11, v24, v25
    v_max3_u32 v11, v11, v26, v27
    v_cmp_eq_u32 vcc, -1, v11
    s_cbranch_vccz L_pok1
    s_mov_b64 exec, vcc
L_poll1:
    buffer_load_dwordx4 v[20:23], v58, s[44:47], 0 offen sc1
    buffer_load_dwordx4 v[24:27], v58, s[44:47], 0 offen offset:16 sc1
    s_add_u32 s75, s75, 1
L_pchk1:
    s_waitcnt vmcnt(1)
    v_max3_u32 v11, v20, v21, v22
    v_max_u32 v11, v11, v23
    s_waitcnt vmcnt(0)
    v_max3_u32 v11, v11, v24, v25
    v_max3_u32 v11, v11, v26, v27
    v_cmp_eq_u32 vcc, -1, v11
    s_cbranch_vccz L_pok1
    s_mov_b64 exec, vcc
    s_cmp_lt_u32 s75, 4194304
    s_cbranch_scc1 L_poll1
L_pok1:
    s_mov_b64 exec, -1
    v_max3_f32 v28, v20, v21, v22
    v_max_f32 v28, v28, v23
    v_sub_f32 v20, v20, v28
    v_sub_f32 v21, v21, v28
    v_sub_f32 v22, v22, v28
    v_sub_f32 v23, v23, v28
    v_exp_f32 v20, v20
    v_exp_f32 v21, v21
    v_exp_f32 v22, v22
    v_exp_f32 v23, v23
    s_nop 0
    v_mul_f32 v28, v20, v24
    v_fmac_f32 v28, v21, v25
    v_fmac_f32 v28, v22, v26
    v_fmac_f32 v28, v23, v27
    v_rcp_f32 v28, v28
    s_nop 0
    v_mul_f32 v20, v20, v28
    v_mul_f32 v21, v21, v28
    v_mul_f32 v22, v22, v28
    v_mul_f32 v23, v23, v28
    v_lshlrev_b32 v18, 16, v19
    v_and_b32 v19, 0xffff0000, v19
    s_waitcnt lgkmcnt(0)
    s_mov_b32 s75, 0
    s_mov_b32 exec_lo, 0xff00ff
    s_mov_b32 exec_hi, 0xff00ff
    s_branch L_pchk2
    .p2align 7
    s_endpgm
    s_endpgm
    s_endpgm
    s_endpgm
    s_endpgm
    s_endpgm
    s_endpgm
L_poll2:
    buffer_load_dwordx4 v[32:35], v57, s[44:47], 0 offen offset:0 sc1
    buffer_load_dwordx4 v[36:39], v57, s[44:47], 0 offen offset:512 sc1
    buffer_load_dwordx4 v[40:43], v57, s[44:47], 0 offen offset:1024 sc1
    buffer_load_dwordx4 v[44:47], v57, s[44:47], 0 offen offset:1536 sc1
    buffer_load_dwordx4 v[48:51], v57, s[44:47], 0 offen offset:2048 sc1
    buffer_load_dwordx4 v[52:55], v57, s[44:47], 0 offen offset:2560 sc1
    s_add_u32 s75, s75, 1
L_pchk2:
    s_waitcnt vmcnt(5)
    v_max3_u32 v11, v32, v33, v34
    v_max_u32 v11, v11, v35
    s_waitcnt vmcnt(4)
    v_max3_u32 v11, v11, v36, v37
    v_max3_u32 v11, v11, v38, v39
    s_waitcnt vmcnt(3)
    v_max3_u32 v11, v11, v40, v41
    v_max3_u32 v11, v11, v42, v43
    s_waitcnt vmcnt(2)
    v_max3_u32 v11, v11, v44, v45
    v_max3_u32 v11, v11, v46, v47
    s_waitcnt vmcnt(1)
    v_max3_u32 v11, v11, v48, v49
    v_max3_u32 v11, v11, v50, v51
    s_waitcnt vmcnt(0)
    v_max3_u32 v11, v11, v52, v53
    v_max3_u32 v11, v11, v54, v55
    v_cmp_eq_u32 vcc, -1, v11
    s_cbranch_vccz L_pok2
    s_mov_b64 exec, vcc
    s_cmp_lt_u32 s75, 4194304
    s_cbranch_scc1 L_poll2
L_pok2:
    s_mov_b64 exec, -1
    v_mfma_f32_16x16x32_bf16 v[160:163], v[32:35], v[64:67], 0
    v_mfma_f32_16x16x32_bf16 v[160:163], v[36:39], v[80:83], v[160:163]
    v_mfma_f32_16x16x32_bf16 v[160:163], v[40:43], v[96:99], v[160:163]
    v_mfma_f32_16x16x32_bf16 v[160:163], v[44:47], v[112:115], v[160:163]
    v_mfma_f32_16x16x32_bf16 v[160:163], v[48:51], v[128:131], v[160:163]
    v_mfma_f32_16x16x32_bf16 v[160:163], v[52:55], v[144:147], v[160:163]
    v_mfma_f32_16x16x32_bf16 v[164:167], v[32:35], v[68:71], 0
    v_mfma_f32_16x16x32_bf16 v[164:167], v[36:39], v[84:87], v[164:167]
    v_mfma_f32_16x16x32_bf16 v[164:167], v[40:43], v[100:103], v[164:167]
    v_mfma_f32_16x16x32_bf16 v[164:167], v[44:47], v[116:119], v[164:167]
    v_mfma_f32_16x16x32_bf16 v[164:167], v[48:51], v[132:135], v[164:167]
    v_mfma_f32_16x16x32_bf16 v[164:167], v[52:55], v[148:151], v[164:167]
    v_mfma_f32_16x16x32_bf16 v[168:171], v[32:35], v[72:75], 0
    v_mfma_f32_16x16x32_bf16 v[168:171], v[36:39], v[88:91], v[168:171]
    v_mfma_f32_16x16x32_bf16 v[168:171], v[40:43], v[104:107], v[168:171]
    v_mul_f32 v160, v160, v20
    v_mfma_f32_16x16x32_bf16 v[168:171], v[44:47], v[120:123], v[168:171]
    v_fmac_f32 v160, v161, v21
    v_mfma_f32_16x16x32_bf16 v[168:171], v[48:51], v[136:139], v[168:171]
    v_fmac_f32 v160, v162, v22
    v_mfma_f32_16x16x32_bf16 v[168:171], v[52:55], v[152:155], v[168:171]
    v_fmac_f32 v160, v163, v23
    v_mfma_f32_16x16x32_bf16 v[172:175], v[32:35], v[76:79], 0
    v_mfma_f32_16x16x32_bf16 v[172:175], v[36:39], v[92:95], v[172:175]
    v_mfma_f32_16x16x32_bf16 v[172:175], v[40:43], v[108:111], v[172:175]
    v_mul_f32 v164, v164, v20
    v_mfma_f32_16x16x32_bf16 v[172:175], v[44:47], v[124:127], v[172:175]
    v_fmac_f32 v164, v165, v21
    v_mfma_f32_16x16x32_bf16 v[172:175], v[48:51], v[140:143], v[172:175]
    v_fmac_f32 v164, v166, v22
    v_mfma_f32_16x16x32_bf16 v[172:175], v[52:55], v[156:159], v[172:175]
    v_fmac_f32 v164, v167, v23
L_epiA:
    s_mov_b32 exec_lo, 0xffffffff
    s_mov_b32 exec_hi, 0x0
    v_mul_f32 v168, v168, v20
    v_fmac_f32 v168, v169, v21
    v_fmac_f32 v168, v170, v22
    v_fmac_f32 v168, v171, v23
    ds_write2_b32 v15, v160, v164 offset0:0 offset1:16
    s_nop 0
    v_mul_f32 v172, v172, v20
    v_fmac_f32 v172, v173, v21
    v_fmac_f32 v172, v174, v22
    v_fmac_f32 v172, v175, v23
    ds_write2_b32 v15, v168, v172 offset0:32 offset1:48
    s_mov_b64 exec, -1
    s_waitcnt lgkmcnt(0)
    s_barrier
    s_cmp_lg_u32 s3, 0
    s_cbranch_scc1 L_finA
    ds_read2st64_b64 v[184:187], v17 offset0:0 offset1:1
    ds_read2st64_b64 v[188:191], v17 offset0:2 offset1:3
    s_waitcnt lgkmcnt(1)
    v_pk_add_f32 v[184:185], v[184:185], v[186:187]
    v_pk_add_f32 v[184:185], v[184:185], v[18:19]
    s_waitcnt lgkmcnt(0)
    v_pk_add_f32 v[188:189], v[188:189], v[190:191]
    v_pk_add_f32 v[184:185], v[184:185], v[188:189]
    v_cvt_pk_bf16_f32 v184, v184, v185
    v_min_u32 v184, -2, v184
    buffer_store_dword v184, v16, s[44:47], s39 offen sc1
    buffer_store_dword v184, v16, s[44:47], s38 offen sc1
L_finA:
    s_branch L_end
L_roleB:
    s_and_b32 s77, s76, 1
    s_lshr_b32 s78, s76, 1
    s_mov_b32 s52, s16
    s_mov_b32 s53, s17
    s_mov_b32 s54, 1966080
    s_mov_b32 s55, 0x20000
    s_cmp_eq_u32 s77, 0
    s_cbranch_scc1 L_bgate
    s_mov_b32 s52, s18
    s_mov_b32 s53, s19
L_bgate:
    v_lshrrev_b32 v20, 3, v1
    v_mul_u32_u24 v20, 3072, v20
    v_and_b32 v21, 1, v24
    v_lshlrev_b32 v21, 1, v21
    v_and_b32 v22, 7, v1
    v_xor_b32 v21, v21, v22
    v_lshl_add_u32 v26, v21, 4, v20
    s_mul_i32 s64, s3, 491520
    s_lshl_b32 s71, s78, 7
    s_add_u32 s64, s64, s71
    s_mul_i32 s72, s3, 21760
    s_add_u32 s72, s72, 23296
    s_mov_b32 s73, s72
    s_waitcnt vmcnt(8)
    buffer_load_dwordx4 a[176:179], v2, s[32:35], s70 offen offset:256 nt
    v_mfma_f32_16x16x32_bf16 v[68:71], v[8:11], a[136:139], v[68:71]
    v_mfma_f32_16x16x32_bf16 v[72:75], v[8:11], a[140:143], v[72:75]
    v_and_b32 v8, v59, v3
    v_and_b32 v9, v59, v4
    v_and_b32 v10, v59, v5
    v_and_b32 v11, v59, v6
    s_nop 1
    v_mfma_f32_16x16x32_bf16 v[64:67], v[8:11], a[144:147], v[64:67]
    s_add_u32 s70, s69, 30
    s_and_b32 s70, s70, 31
    s_mul_i32 s70, s70, 49152
    s_waitcnt vmcnt(8)
    buffer_load_dwordx4 a[180:183], v2, s[32:35], s70 offen offset:0 nt
    v_mfma_f32_16x16x32_bf16 v[68:71], v[8:11], a[148:151], v[68:71]
    s_waitcnt vmcnt(8)
    buffer_load_dwordx4 a[184:187], v2, s[32:35], s70 offen offset:128 nt
    v_mfma_f32_16x16x32_bf16 v[72:75], v[8:11], a[152:155], v[72:75]
    s_waitcnt vmcnt(8)
    buffer_load_dwordx4 a[188:191], v2, s[32:35], s70 offen offset:256 nt
    v_and_b32 v8, v60, v3
    v_and_b32 v9, v60, v4
    v_and_b32 v10, v60, v5
    v_and_b32 v11, v60, v6
    s_nop 1
    v_mfma_f32_16x16x32_bf16 v[64:67], v[8:11], a[156:159], v[64:67]
    s_add_u32 s70, s69, 31
    s_and_b32 s70, s70, 31
    s_mul_i32 s70, s70, 49152
    s_waitcnt vmcnt(8)
    buffer_load_dwordx4 a[192:195], v2, s[32:35], s70 offen offset:0 nt
    v_mfma_f32_16x16x32_bf16 v[68:71], v[8:11], a[160:163], v[68:71]
    s_waitcnt vmcnt(8)
    buffer_load_dwordx4 a[196:199], v2, s[32:35], s70 offen offset:128 nt
    v_mfma_f32_16x16x32_bf16 v[72:75], v[8:11], a[164:167], v[72:75]
    s_waitcnt vmcnt(8)
    buffer_load_dwordx4 a[200:203], v2, s[32:35], s70 offen offset:256 nt
    v_and_b32 v8, v61, v3
    v_and_b32 v9, v61, v4
    v_and_b32 v10, v61, v5
    v_and_b32 v11, v61, v6
    s_nop 1
    v_mfma_f32_16x16x32_bf16 v[64:67], v[8:11], a[168:171], v[64:67]
    s_waitcnt vmcnt(8)
    v_mfma_f32_16x16x32_bf16 v[68:71], v[8:11], a[172:175], v[68:71]
    s_mov_b32 m0, s73
    s_add_u32 s73, s73, 1088
    buffer_load_dwordx4 v26, s[52:55], s64 offen nt lds
    s_add_u32 s64, s64, 24576
    s_waitcnt vmcnt(7)
    v_mfma_f32_16x16x32_bf16 v[72:75], v[8:11], a[176:179], v[72:75]
    s_mov_b32 m0, s73
    s_add_u32 s73, s73, 1088
    buffer_load_dwordx4 v26, s[52:55], s64 offen nt lds
    s_add_u32 s64, s64, 24576
    v_and_b32 v8, v62, v3
    v_and_b32 v9, v62, v4
    v_and_b32 v10, v62, v5
    v_and_b32 v11, v62, v6
    s_waitcnt vmcnt(7)
    s_nop 0
    v_mfma_f32_16x16x32_bf16 v[64:67], v[8:11], a[180:183], v[64:67]
    s_waitcnt vmcnt(6)
    v_mfma_f32_16x16x32_bf16 v[68:71], v[8:11], a[184:187], v[68:71]
    s_mov_b32 m0, s73
    s_add_u32 s73, s73, 1088
    buffer_load_dwordx4 v26, s[52:55], s64 offen nt lds
    s_add_u32 s64, s64, 24576
    s_waitcnt vmcnt(6)
    v_mfma_f32_16x16x32_bf16 v[72:75], v[8:11], a[188:191], v[72:75]
    v_and_b32 v8, v63, v3
    v_and_b32 v9, v63, v4
    v_and_b32 v10, v63, v5
    v_and_b32 v11, v63, v6
    s_waitcnt vmcnt(5)
    s_nop 0
    v_mfma_f32_16x16x32_bf16 v[64:67], v[8:11], a[192:195], v[64:67]
    s_mov_b32 m0, s73
    s_add_u32 s73, s73, 1088
    buffer_load_dwordx4 v26, s[52:55], s64 offen nt lds
    s_add_u32 s64, s64, 24576
    s_waitcnt vmcnt(5)
    v_mfma_f32_16x16x32_bf16 v[68:71], v[8:11], a[196:199], v[68:71]
    s_waitcnt vmcnt(4)
    v_mfma_f32_16x16x32_bf16 v[72:75], v[8:11], a[200:203], v[72:75]
    s_mov_b32 exec_lo, 0xff00ff
    s_mov_b32 exec_hi, 0xff00ff00
    ds_write_b128 v19, v[64:67] offset:0
    s_nop 2
    ds_write_b128 v19, v[68:71] offset:256
    s_nop 0
    ds_write_b128 v19, v[72:75] offset:512
    s_mov_b64 exec, -1
    s_waitcnt lgkmcnt(0)
    s_barrier
    s_cmp_ge_u32 s3, 2
    s_cbranch_scc1 L_onoredB
    ds_read2st64_b64 v[32:35], v13 offset0:0 offset1:2
    ds_read2st64_b64 v[36:39], v13 offset0:4 offset1:6
    ds_read2st64_b64 v[40:43], v13 offset0:8 offset1:10
    ds_read2st64_b64 v[44:47], v13 offset0:12 offset1:14
    s_waitcnt lgkmcnt(2)
    v_pk_add_f32 v[32:33], v[32:33], v[34:35]
    v_pk_add_f32 v[36:37], v[36:37], v[38:39]
    v_pk_mul_f32 v[32:33], v[32:33], v[80:81] op_sel_hi:[1,0]
    v_pk_fma_f32 v[32:33], v[36:37], v[80:81], v[32:33] op_sel:[0,1,0] op_sel_hi:[1,1,1]
    s_waitcnt lgkmcnt(0)
    v_pk_add_f32 v[40:41], v[40:41], v[42:43]
    v_pk_add_f32 v[44:45], v[44:45], v[46:47]
    v_pk_fma_f32 v[32:33], v[40:41], v[82:83], v[32:33] op_sel_hi:[1,0,1]
    v_pk_fma_f32 v[32:33], v[44:45], v[82:83], v[32:33] op_sel:[0,1,0] op_sel_hi:[1,1,1]
    v_cvt_pk_bf16_f32 v32, v32, v33
    v_min_u32 v32, -2, v32
    buffer_store_dword v32, v12, s[44:47], s39 offen sc1
    buffer_store_dword v32, v12, s[44:47], s38 offen sc1
L_onoredB:
    s_barrier
    s_mov_b32 m0, s73
    s_add_u32 s73, s73, 1088
    buffer_load_dwordx4 v26, s[52:55], s64 offen nt lds
    s_add_u32 s64, s64, 24576
    s_mov_b32 m0, s73
    s_add_u32 s73, s73, 1088
    buffer_load_dwordx4 v26, s[52:55], s64 offen nt lds
    s_add_u32 s64, s64, 24576
    s_mov_b32 m0, s73
    s_add_u32 s73, s73, 1088
    buffer_load_dwordx4 v26, s[52:55], s64 offen nt lds
    s_add_u32 s64, s64, 24576
    s_mov_b32 m0, s73
    s_add_u32 s73, s73, 1088
    buffer_load_dwordx4 v26, s[52:55], s64 offen nt lds
    s_add_u32 s64, s64, 24576
    s_mov_b32 m0, s73
    s_add_u32 s73, s73, 1088
    buffer_load_dwordx4 v26, s[52:55], s64 offen nt lds
    s_add_u32 s64, s64, 24576
    s_mov_b32 m0, s73
    s_add_u32 s73, s73, 1088
    buffer_load_dwordx4 v26, s[52:55], s64 offen nt lds
    s_add_u32 s64, s64, 24576
    s_mov_b32 m0, s73
    s_add_u32 s73, s73, 1088
    buffer_load_dwordx4 v26, s[52:55], s64 offen nt lds
    s_add_u32 s64, s64, 24576
    s_mov_b32 m0, s73
    s_add_u32 s73, s73, 1088
    buffer_load_dwordx4 v26, s[52:55], s64 offen nt lds
    s_add_u32 s64, s64, 24576
    s_mov_b32 m0, s73
    s_add_u32 s73, s73, 1088
    buffer_load_dwordx4 v26, s[52:55], s64 offen nt lds
    s_add_u32 s64, s64, 24576
    s_mov_b32 m0, s73
    s_add_u32 s73, s73, 1088
    buffer_load_dwordx4 v26, s[52:55], s64 offen nt lds
    s_add_u32 s64, s64, 24576
    s_mov_b32 m0, s73
    s_add_u32 s73, s73, 1088
    buffer_load_dwordx4 v26, s[52:55], s64 offen nt lds
    s_add_u32 s64, s64, 24576
    s_mov_b32 m0, s73
    s_add_u32 s73, s73, 1088
    buffer_load_dwordx4 v26, s[52:55], s64 offen nt lds
    s_add_u32 s64, s64, 24576
    v_lshrrev_b32 v7, 4, v1
    v_bfe_u32 v8, v1, 2, 2
    v_and_b32 v9, 3, v1
    v_and_b32 v10, 15, v1
    s_mul_i32 s71, s3, 5
    s_lshr_b32 s74, s71, 1
    s_and_b32 s4, s71, 1
    s_lshl2_add_u32 s4, s74, s4
    s_lshl_b32 s4, s4, 12
    s_add_u32 s4, s4, 527360
    s_add_u32 s71, s71, 1
    s_lshr_b32 s74, s71, 1
    s_and_b32 s5, s71, 1
    s_lshl2_add_u32 s5, s74, s5
    s_lshl_b32 s5, s5, 12
    s_add_u32 s5, s5, 527360
    s_add_u32 s71, s71, 1
    s_lshr_b32 s74, s71, 1
    s_and_b32 s6, s71, 1
    s_lshl2_add_u32 s6, s74, s6
    s_lshl_b32 s6, s6, 12
    s_add_u32 s6, s6, 527360
    s_add_u32 s71, s71, 1
    s_lshr_b32 s74, s71, 1
    s_and_b32 s7, s71, 1
    s_lshl2_add_u32 s7, s74, s7
    s_lshl_b32 s7, s7, 12
    s_add_u32 s7, s7, 527360
    s_add_u32 s71, s71, 1
    s_lshr_b32 s74, s71, 1
    s_and_b32 s8, s71, 1
    s_lshl2_add_u32 s8, s74, s8
    s_lshl_b32 s8, s8, 12
    s_add_u32 s8, s8, 527360
    s_add_u32 s71, s71, 1
    s_mov_b32 s71, s38
    v_and_b32 v15, 7, v1
    v_lshlrev_b32 v15, 7, v15
    v_bfe_u32 v16, v1, 3, 1
    v_lshl_add_u32 v15, v16, 6, v15
    v_lshl_add_u32 v15, v7, 4, v15
    v_add_u32 v15, s71, v15
    s_mov_b32 s74, 4096
    v_mov_b32 v20, 0x3f803f80
    v_mov_b32 v21, 0x3f803f80
    v_mov_b32 v22, 0x3f803f80
    v_mov_b32 v23, 0x3f803f80
    s_lshl_b32 s71, s3, 10
    v_lshlrev_b32 v17, 4, v1
    v_add_u32 v17, 16960, v17
    v_add_u32 v16, s71, v17
    s_lshl_b32 s71, s3, 9
    v_lshlrev_b32 v57, 3, v1
    v_add_u32 v57, 21056, v57
    v_add_u32 v58, s71, v57
    s_lshr_b32 s71, s76, 2
    s_lshr_b32 s75, s71, 1
    s_and_b32 s71, s71, 1
    s_lshl2_add_u32 s71, s75, s71
    s_lshl_b32 s71, s71, 12
    s_add_u32 s71, s71, 691200
    s_and_b32 s75, s76, 3
    s_lshl_b32 s75, s75, 8
    s_add_u32 s71, s71, s75
    v_lshl_add_u32 v18, v1, 2, s71
    v_lshrrev_b32 v11, 5, v1
    v_bfe_u32 v12, v1, 3, 1
    v_cmp_eq_u32 vcc, v11, v12
    s_nop 1
    v_cndmask_b32 v19, 0, -1, vcc
    v_mul_u32_u24 v11, 1088, v7
    v_lshl_add_u32 v11, v8, 7, v11
    v_lshl_add_u32 v11, v9, 3, v11
    v_add_u32 v11, s72, v11
    v_lshrrev_b32 v12, 1, v8
    v_lshl_add_u32 v13, v12, 5, v11
    v_xor_b32 v12, 1, v12
    v_lshl_add_u32 v14, v12, 5, v11
    v_mov_b32 v56, v18
    v_mov_b32 v18, 1073741824
    s_mov_b32 s69, 1
    s_branch L_postB
L_realB:
    s_mov_b64 exec, -1
    v_mov_b32 v18, v56
    s_mov_b32 s69, 0
    v_and_b32 v12, 1, v7
    v_cmp_eq_u32 vcc, 1, v12
    s_mov_b32 m0, s73
    s_add_u32 s73, s73, 1088
    buffer_load_dwordx4 v26, s[52:55], s64 offen nt lds
    s_add_u32 s64, s64, 24576
    s_waitcnt vmcnt(13)
    ds_read_b64_tr_b16 v[64:65], v13 offset:0
    ds_read_b64_tr_b16 v[66:67], v13 offset:512
    ds_read_b64_tr_b16 v[68:69], v14 offset:0
    ds_read_b64_tr_b16 v[70:71], v14 offset:512
    ds_read_b64_tr_b16 v[72:73], v13 offset:64
    ds_read_b64_tr_b16 v[74:75], v13 offset:576
    ds_read_b64_tr_b16 v[76:77], v14 offset:64
    ds_read_b64_tr_b16 v[78:79], v14 offset:576
    s_waitcnt vmcnt(9)
    s_waitcnt lgkmcnt(0)
    v_mfma_f32_16x16x32_bf16 v[160:163], v[20:23], v[64:67], 0
    v_mfma_f32_16x16x32_bf16 v[164:167], v[20:23], v[68:71], 0
    v_mfma_f32_16x16x32_bf16 v[168:171], v[20:23], v[72:75], 0
    v_mfma_f32_16x16x32_bf16 v[172:175], v[20:23], v[76:79], 0
    ds_read_b64_tr_b16 v[80:81], v13 offset:4352
    ds_read_b64_tr_b16 v[82:83], v13 offset:4864
    ds_read_b64_tr_b16 v[84:85], v14 offset:4352
    ds_read_b64_tr_b16 v[86:87], v14 offset:4864
    ds_read_b64_tr_b16 v[88:89], v13 offset:4416
    ds_read_b64_tr_b16 v[90:91], v13 offset:4928
    ds_read_b64_tr_b16 v[92:93], v14 offset:4416
    ds_read_b64_tr_b16 v[94:95], v14 offset:4928
    s_mov_b32 m0, s73
    s_add_u32 s73, s73, 1088
    buffer_load_dwordx4 v26, s[52:55], s64 offen nt lds
    s_add_u32 s64, s64, 24576
    s_mov_b32 m0, s73
    s_add_u32 s73, s73, 1088
    buffer_load_dwordx4 v26, s[52:55], s64 offen nt lds
    s_add_u32 s64, s64, 24576
    s_mov_b32 m0, s73
    s_add_u32 s73, s73, 1088
    buffer_load_dwordx4 v26, s[52:55], s64 offen nt lds
    s_add_u32 s64, s64, 24576
    s_waitcnt vmcnt(8)
    s_waitcnt lgkmcnt(0)
    v_mfma_f32_16x16x32_bf16 v[160:163], v[20:23], v[80:83], v[160:163]
    v_mfma_f32_16x16x32_bf16 v[164:167], v[20:23], v[84:87], v[164:167]
    v_mfma_f32_16x16x32_bf16 v[168:171], v[20:23], v[88:91], v[168:171]
    v_mfma_f32_16x16x32_bf16 v[172:175], v[20:23], v[92:95], v[172:175]
    ds_read_b64_tr_b16 v[96:97], v13 offset:8704
    ds_read_b64_tr_b16 v[98:99], v13 offset:9216
    ds_read_b64_tr_b16 v[100:101], v14 offset:8704
    ds_read_b64_tr_b16 v[102:103], v14 offset:9216
    ds_read_b64_tr_b16 v[104:105], v13 offset:8768
    ds_read_b64_tr_b16 v[106:107], v13 offset:9280
    ds_read_b64_tr_b16 v[108:109], v14 offset:8768
    ds_read_b64_tr_b16 v[110:111], v14 offset:9280
    s_waitcnt vmcnt(4)
    s_waitcnt lgkmcnt(0)
    v_mfma_f32_16x16x32_bf16 v[160:163], v[20:23], v[96:99], v[160:163]
    v_mfma_f32_16x16x32_bf16 v[164:167], v[20:23], v[100:103], v[164:167]
    v_mfma_f32_16x16x32_bf16 v[168:171], v[20:23], v[104:107], v[168:171]
    v_mfma_f32_16x16x32_bf16 v[172:175], v[20:23], v[108:111], v[172:175]
    ds_read_b64_tr_b16 v[112:113], v13 offset:13056
    ds_read_b64_tr_b16 v[114:115], v13 offset:13568
    ds_read_b64_tr_b16 v[116:117], v14 offset:13056
    ds_read_b64_tr_b16 v[118:119], v14 offset:13568
    ds_read_b64_tr_b16 v[120:121], v13 offset:13120
    ds_read_b64_tr_b16 v[122:123], v13 offset:13632
    ds_read_b64_tr_b16 v[124:125], v14 offset:13120
    ds_read_b64_tr_b16 v[126:127], v14 offset:13632
    s_waitcnt vmcnt(0)
    buffer_load_dwordx4 v[32:35], v15, s[44:47], s4 offen sc1
    buffer_load_dwordx4 v[36:39], v15, s[44:47], s5 offen sc1
    buffer_load_dwordx4 v[40:43], v15, s[44:47], s6 offen sc1
    buffer_load_dwordx4 v[44:47], v15, s[44:47], s7 offen sc1
    buffer_load_dwordx4 v[48:51], v15, s[44:47], s8 offen sc1
    s_waitcnt lgkmcnt(0)
    v_mfma_f32_16x16x32_bf16 v[160:163], v[20:23], v[112:115], v[160:163]
    v_mfma_f32_16x16x32_bf16 v[164:167], v[20:23], v[116:119], v[164:167]
    v_mfma_f32_16x16x32_bf16 v[168:171], v[20:23], v[120:123], v[168:171]
    v_mfma_f32_16x16x32_bf16 v[172:175], v[20:23], v[124:127], v[172:175]
    ds_read_b64_tr_b16 v[128:129], v13 offset:17408
    ds_read_b64_tr_b16 v[130:131], v13 offset:17920
    ds_read_b64_tr_b16 v[132:133], v14 offset:17408
    ds_read_b64_tr_b16 v[134:135], v14 offset:17920
    ds_read_b64_tr_b16 v[136:137], v13 offset:17472
    ds_read_b64_tr_b16 v[138:139], v13 offset:17984
    ds_read_b64_tr_b16 v[140:141], v14 offset:17472
    ds_read_b64_tr_b16 v[142:143], v14 offset:17984
    s_waitcnt lgkmcnt(0)
    v_mfma_f32_16x16x32_bf16 v[160:163], v[20:23], v[128:131], v[160:163]
    v_mfma_f32_16x16x32_bf16 v[164:167], v[20:23], v[132:135], v[164:167]
    v_mfma_f32_16x16x32_bf16 v[168:171], v[20:23], v[136:139], v[168:171]
    v_mfma_f32_16x16x32_bf16 v[172:175], v[20:23], v[140:143], v[172:175]
    s_nop 5
    v_cndmask_b32 v24, v160, v164, vcc
    s_nop 0
    v_cndmask_b32 v25, v168, v172, vcc
    ds_write_b64 v58, v[24:25]
    s_waitcnt lgkmcnt(0)
    s_barrier
    ds_read2st64_b64 v[24:27], v57 offset0:0 offset1:1
    ds_read2st64_b64 v[28:31], v57 offset0:2 offset1:3
    s_waitcnt lgkmcnt(0)
    v_pk_add_f32 v[24:25], v[24:25], v[26:27]
    v_pk_add_f32 v[28:29], v[28:29], v[30:31]
    v_pk_add_f32 v[24:25], v[24:25], v[28:29]
    s_mov_b32 s75, 0
    s_branch L_pchk3
    .p2align 7
    s_endpgm
    s_endpgm
    s_endpgm
    s_endpgm
    s_endpgm
    s_endpgm
    s_endpgm
L_poll3:
    s_mov_b64 exec, s[12:13]
    buffer_load_dwordx4 v[32:35], v15, s[44:47], s4 offen sc1
    s_mov_b64 exec, s[14:15]
    buffer_load_dwordx4 v[36:39], v15, s[44:47], s5 offen sc1
    s_mov_b64 exec, s[16:17]
    buffer_load_dwordx4 v[40:43], v15, s[44:47], s6 offen sc1
    s_mov_b64 exec, s[18:19]
    buffer_load_dwordx4 v[44:47], v15, s[44:47], s7 offen sc1
    s_mov_b64 exec, s[20:21]
    buffer_load_dwordx4 v[48:51], v15, s[44:47], s8 offen sc1
    s_add_u32 s75, s75, 1
    s_mov_b64 exec, -1
    s_cmp_ge_u32 s75, 4194304
    s_cbranch_scc1 L_pok3
L_pchk3:
    s_waitcnt vmcnt(4)
    v_max3_u32 v11, v32, v33, v34
    v_max_u32 v11, v11, v35
    v_cmp_eq_u32 s[12:13], -1, v11
    s_waitcnt vmcnt(3)
    v_max3_u32 v12, v36, v37, v38
    v_max_u32 v12, v12, v39
    v_cmp_eq_u32 s[14:15], -1, v12
    s_waitcnt vmcnt(2)
    v_max3_u32 v11, v40, v41, v42
    v_max_u32 v11, v11, v43
    s_or_b64 s[58:59], s[12:13], s[14:15]
    v_cmp_eq_u32 s[16:17], -1, v11
    s_waitcnt vmcnt(1)
    v_max3_u32 v12, v44, v45, v46
    v_max_u32 v12, v12, v47
    s_or_b64 s[58:59], s[58:59], s[16:17]
    v_cmp_eq_u32 s[18:19], -1, v12
    s_waitcnt vmcnt(0)
    v_max3_u32 v11, v48, v49, v50
    v_max_u32 v11, v11, v51
    s_or_b64 s[58:59], s[58:59], s[18:19]
    v_cmp_eq_u32 s[20:21], -1, v11
    s_or_b64 s[58:59], s[58:59], s[20:21]
    s_cbranch_scc1 L_poll3
L_pok3:
L_postB:
    v_mfma_f32_16x16x32_bf16 v[176:179], v[32:35], v[32:35], 0
    v_mfma_f32_16x16x32_bf16 v[176:179], v[36:39], v[36:39], v[176:179]
    v_mfma_f32_16x16x32_bf16 v[176:179], v[40:43], v[40:43], v[176:179]
    v_mfma_f32_16x16x32_bf16 v[176:179], v[44:47], v[44:47], v[176:179]
    v_mfma_f32_16x16x32_bf16 v[176:179], v[48:51], v[48:51], v[176:179]
    v_mfma_f32_16x16x32_bf16 v[180:183], v[32:35], v[20:23], 0
    v_mfma_f32_16x16x32_bf16 v[180:183], v[36:39], v[20:23], v[180:183]
    v_mfma_f32_16x16x32_bf16 v[180:183], v[40:43], v[20:23], v[180:183]
    v_mfma_f32_16x16x32_bf16 v[180:183], v[44:47], v[20:23], v[180:183]
    v_mfma_f32_16x16x32_bf16 v[180:183], v[48:51], v[20:23], v[180:183]
    v_mfma_f32_16x16x32_bf16 v[160:163], v[32:35], v[64:67], 0
    v_mfma_f32_16x16x32_bf16 v[160:163], v[36:39], v[80:83], v[160:163]
    v_mfma_f32_16x16x32_bf16 v[160:163], v[40:43], v[96:99], v[160:163]
    v_mfma_f32_16x16x32_bf16 v[160:163], v[44:47], v[112:115], v[160:163]
    v_add_f32 v31, v176, v177
    v_add_f32 v11, v178, v179
    v_mfma_f32_16x16x32_bf16 v[160:163], v[48:51], v[128:131], v[160:163]
    v_add_f32 v31, v31, v11
    v_and_b32 v31, v31, v19
    v_mfma_f32_16x16x32_bf16 v[164:167], v[32:35], v[68:71], 0
    s_nop 0
    v_mfma_f32_16x16x32_bf16 v[164:167], v[36:39], v[84:87], v[164:167]
    v_add_f32_dpp v31, v31, v31 quad_perm:[1,0,3,2] row_mask:0xf bank_mask:0xf
    v_add_f32 v30, v180, v181
    v_mfma_f32_16x16x32_bf16 v[164:167], v[40:43], v[100:103], v[164:167]
    v_add_f32_dpp v31, v31, v31 quad_perm:[2,3,0,1] row_mask:0xf bank_mask:0xf
    v_add_f32 v11, v182, v183
    v_mfma_f32_16x16x32_bf16 v[164:167], v[44:47], v[116:119], v[164:167]
    v_add_f32_dpp v31, v31, v31 row_half_mirror row_mask:0xf bank_mask:0xf
    v_add_f32 v30, v30, v11
    v_mfma_f32_16x16x32_bf16 v[164:167], v[48:51], v[132:135], v[164:167]
    v_add_f32_dpp v31, v31, v31 row_ror:8 row_mask:0xf bank_mask:0xf
    v_mov_b32 v11, v30
    v_mfma_f32_16x16x32_bf16 v[168:171], v[32:35], v[72:75], 0
    v_mov_b32 v12, v31
    v_add_f32 v160, v160, v161
    v_mfma_f32_16x16x32_bf16 v[168:171], v[36:39], v[88:91], v[168:171]
    v_permlane16_swap_b32 v30, v11
    v_permlane16_swap_b32 v31, v12
    v_mfma_f32_16x16x32_bf16 v[168:171], v[40:43], v[104:107], v[168:171]
    v_add_f32 v30, v30, v11
    v_add_f32 v31, v31, v12
    v_mfma_f32_16x16x32_bf16 v[168:171], v[44:47], v[120:123], v[168:171]
    v_add_f32 v162, v162, v163
    v_add_f32 v160, v160, v162
    v_mfma_f32_16x16x32_bf16 v[168:171], v[48:51], v[136:139], v[168:171]
    v_add_f32 v164, v164, v165
    v_add_f32 v166, v166, v167
    v_mfma_f32_16x16x32_bf16 v[172:175], v[32:35], v[76:79], 0
    v_add_f32 v164, v164, v166
    v_mfma_f32_16x16x32_bf16 v[172:175], v[36:39], v[92:95], v[172:175]
    s_nop 0
    v_mfma_f32_16x16x32_bf16 v[172:175], v[40:43], v[108:111], v[172:175]
    v_permlane16_swap_b32 v160, v164
    v_add_f32 v28, v160, v164
    v_mfma_f32_16x16x32_bf16 v[172:175], v[44:47], v[124:127], v[172:175]
    v_mfma_f32_16x16x32_bf16 v[172:175], v[48:51], v[140:143], v[172:175]
    v_add_f32 v168, v168, v169
    v_add_f32 v170, v170, v171
    v_add_f32 v168, v168, v170
    s_nop 4
    v_add_f32 v172, v172, v173
    v_add_f32 v174, v174, v175
    v_add_f32 v172, v172, v174
    s_nop 1
    v_permlane16_swap_b32 v168, v172
    v_add_f32 v29, v168, v172
    ds_write_b128 v16, v[28:31]
    s_waitcnt lgkmcnt(0)
    s_barrier
    s_cmp_lg_u32 s3, 0
    s_cbranch_scc1 L_finB
    ds_read_b128 v[184:187], v17 offset:1024
    ds_read_b128 v[188:191], v17 offset:2048
    ds_read_b128 v[192:195], v17 offset:3072
    s_waitcnt lgkmcnt(2)
    v_pk_add_f32 v[30:31], v[30:31], v[186:187]
    v_pk_add_f32 v[28:29], v[28:29], v[184:185]
    s_waitcnt lgkmcnt(0)
    v_pk_add_f32 v[190:191], v[190:191], v[194:195]
    v_pk_add_f32 v[188:189], v[188:189], v[192:193]
    v_pk_add_f32 v[30:31], v[30:31], v[190:191]
    v_pk_add_f32 v[28:29], v[28:29], v[188:189]
    v_mul_f32 v30, 0x3acccccd, v30
    v_mul_f32 v31, 0x3acccccd, v31
    v_fma_f32 v31, -v30, v30, v31
    v_max_f32 v31, 0, v31
    v_add_f32 v31, 0x3727c5ac, v31
    v_rsq_f32 v31, v31
    v_fma_f32 v28, -v30, v24, v28
    v_fma_f32 v29, -v30, v25, v29
    s_cmp_lg_u32 s77, 0
    v_mul_f32 v28, v28, v31
    v_mul_f32 v29, v29, v31
    s_cbranch_scc1 L_bup
    v_mul_f32 v28, 0xbfb8aa3b, v28
    v_mul_f32 v29, 0xbfb8aa3b, v29
    v_exp_f32 v28, v28
    v_exp_f32 v29, v29
    v_add_f32 v28, 1.0, v28
    v_add_f32 v29, 1.0, v29
    v_rcp_f32 v28, v28
    v_rcp_f32 v29, v29
L_bup:
    s_nop 0
    v_cvt_pk_bf16_f32 v28, v28, v29
    v_min_u32 v28, -2, v28
    buffer_store_dword v28, v18, s[44:47], s39 offen sc1
    buffer_store_dword v28, v18, s[44:47], s38 offen sc1
L_finB:
    s_cmp_eq_u32 s69, 1
    s_cbranch_scc1 L_realB
    s_branch L_end
L_roleC:
    s_mov_b32 s52, s20
    s_mov_b32 s53, s21
    s_mov_b32 s54, 1966080
    s_mov_b32 s55, 0x20000
    s_mov_b32 s60, s22
    s_mov_b32 s61, s23
    s_mov_b32 s62, 2560
    s_mov_b32 s63, 0x20000
    v_lshrrev_b32 v20, 1, v1
    v_and_b32 v21, 0x13, v20
    v_bfe_u32 v22, v20, 2, 1
    v_lshl_add_u32 v21, v22, 3, v21
    v_bfe_u32 v22, v20, 3, 1
    v_lshl_add_u32 v21, v22, 2, v21
    v_and_b32 v22, 1, v21
    v_lshrrev_b32 v21, 1, v21
    v_lshl_add_u32 v21, v22, 5, v21
    v_mul_u32_u24 v20, 1280, v21
    v_and_b32 v21, 1, v1
    v_lshl_add_u32 v26, v21, 4, v20
    s_mul_i32 s64, s3, 491520
    s_lshl_b32 s71, s76, 5
    s_add_u32 s64, s64, s71
    s_mul_i32 s72, s3, 12288
    s_add_u32 s72, s72, 23296
    s_mov_b32 s73, s72
    s_waitcnt vmcnt(8)
    buffer_load_dwordx4 a[176:179], v2, s[32:35], s70 offen offset:256 nt
    v_mfma_f32_16x16x32_bf16 v[68:71], v[8:11], a[136:139], v[68:71]
    v_mfma_f32_16x16x32_bf16 v[72:75], v[8:11], a[140:143], v[72:75]
    v_and_b32 v8, v59, v3
    v_and_b32 v9, v59, v4
    v_and_b32 v10, v59, v5
    v_and_b32 v11, v59, v6
    s_nop 1
    v_mfma_f32_16x16x32_bf16 v[64:67], v[8:11], a[144:147], v[64:67]
    s_add_u32 s70, s69, 30
    s_and_b32 s70, s70, 31
    s_mul_i32 s70, s70, 49152
    s_waitcnt vmcnt(8)
    buffer_load_dwordx4 a[180:183], v2, s[32:35], s70 offen offset:0 nt
    v_mfma_f32_16x16x32_bf16 v[68:71], v[8:11], a[148:151], v[68:71]
    s_waitcnt vmcnt(8)
    buffer_load_dwordx4 a[184:187], v2, s[32:35], s70 offen offset:128 nt
    v_mfma_f32_16x16x32_bf16 v[72:75], v[8:11], a[152:155], v[72:75]
    s_waitcnt vmcnt(8)
    buffer_load_dwordx4 a[188:191], v2, s[32:35], s70 offen offset:256 nt
    v_and_b32 v8, v60, v3
    v_and_b32 v9, v60, v4
    v_and_b32 v10, v60, v5
    v_and_b32 v11, v60, v6
    s_nop 1
    v_mfma_f32_16x16x32_bf16 v[64:67], v[8:11], a[156:159], v[64:67]
    s_add_u32 s70, s69, 31
    s_and_b32 s70, s70, 31
    s_mul_i32 s70, s70, 49152
    s_waitcnt vmcnt(8)
    buffer_load_dwordx4 a[192:195], v2, s[32:35], s70 offen offset:0 nt
    v_mfma_f32_16x16x32_bf16 v[68:71], v[8:11], a[160:163], v[68:71]
    s_waitcnt vmcnt(8)
    buffer_load_dwordx4 a[196:199], v2, s[32:35], s70 offen offset:128 nt
    v_mfma_f32_16x16x32_bf16 v[72:75], v[8:11], a[164:167], v[72:75]
    s_waitcnt vmcnt(8)
    buffer_load_dwordx4 a[200:203], v2, s[32:35], s70 offen offset:256 nt
    v_and_b32 v8, v61, v3
    v_and_b32 v9, v61, v4
    v_and_b32 v10, v61, v5
    v_and_b32 v11, v61, v6
    s_nop 1
    v_mfma_f32_16x16x32_bf16 v[64:67], v[8:11], a[168:171], v[64:67]
    s_waitcnt vmcnt(8)
    v_mfma_f32_16x16x32_bf16 v[68:71], v[8:11], a[172:175], v[68:71]
    s_mov_b32 m0, s73
    s_add_u32 s73, s73, 1024
    buffer_load_dwordx4 v26, s[52:55], s64 offen  lds
    s_add_u32 s64, s64, 20480
    s_waitcnt vmcnt(7)
    v_mfma_f32_16x16x32_bf16 v[72:75], v[8:11], a[176:179], v[72:75]
    v_and_b32 v8, v62, v3
    v_and_b32 v9, v62, v4
    v_and_b32 v10, v62, v5
    v_and_b32 v11, v62, v6
    s_waitcnt vmcnt(6)
    s_nop 0
    v_mfma_f32_16x16x32_bf16 v[64:67], v[8:11], a[180:183], v[64:67]
    s_waitcnt vmcnt(5)
    v_mfma_f32_16x16x32_bf16 v[68:71], v[8:11], a[184:187], v[68:71]
    s_mov_b32 m0, s73
    s_add_u32 s73, s73, 1024
    buffer_load_dwordx4 v26, s[52:55], s64 offen  lds
    s_add_u32 s64, s64, 61440
    s_waitcnt vmcnt(5)
    v_mfma_f32_16x16x32_bf16 v[72:75], v[8:11], a[188:191], v[72:75]
    v_and_b32 v8, v63, v3
    v_and_b32 v9, v63, v4
    v_and_b32 v10, v63, v5
    v_and_b32 v11, v63, v6
    s_waitcnt vmcnt(4)
    s_nop 0
    v_mfma_f32_16x16x32_bf16 v[64:67], v[8:11], a[192:195], v[64:67]
    s_waitcnt vmcnt(3)
    v_mfma_f32_16x16x32_bf16 v[68:71], v[8:11], a[196:199], v[68:71]
    s_waitcnt vmcnt(2)
    v_mfma_f32_16x16x32_bf16 v[72:75], v[8:11], a[200:203], v[72:75]
    s_mov_b32 exec_lo, 0xff00ff
    s_mov_b32 exec_hi, 0xff00ff00
    s_nop 1
    ds_write_b128 v19, v[64:67] offset:0
    s_nop 0
    ds_write_b128 v19, v[68:71] offset:256
    s_nop 0
    ds_write_b128 v19, v[72:75] offset:512
    s_mov_b64 exec, -1
    s_waitcnt lgkmcnt(0)
    s_barrier
    s_cmp_ge_u32 s3, 2
    s_cbranch_scc1 L_onoredC
    ds_read2st64_b64 v[32:35], v13 offset0:0 offset1:2
    ds_read2st64_b64 v[36:39], v13 offset0:4 offset1:6
    ds_read2st64_b64 v[40:43], v13 offset0:8 offset1:10
    ds_read2st64_b64 v[44:47], v13 offset0:12 offset1:14
    s_waitcnt lgkmcnt(2)
    v_pk_add_f32 v[32:33], v[32:33], v[34:35]
    v_pk_add_f32 v[36:37], v[36:37], v[38:39]
    v_pk_mul_f32 v[32:33], v[32:33], v[80:81] op_sel_hi:[1,0]
    v_pk_fma_f32 v[32:33], v[36:37], v[80:81], v[32:33] op_sel:[0,1,0] op_sel_hi:[1,1,1]
    s_waitcnt lgkmcnt(0)
    v_pk_add_f32 v[40:41], v[40:41], v[42:43]
    v_pk_add_f32 v[44:45], v[44:45], v[46:47]
    v_pk_fma_f32 v[32:33], v[40:41], v[82:83], v[32:33] op_sel_hi:[1,0,1]
    v_pk_fma_f32 v[32:33], v[44:45], v[82:83], v[32:33] op_sel:[0,1,0] op_sel_hi:[1,1,1]
    v_cvt_pk_bf16_f32 v32, v32, v33
    v_min_u32 v32, -2, v32
    buffer_store_dword v32, v12, s[44:47], s39 offen sc1
    buffer_store_dword v32, v12, s[44:47], s38 offen sc1
L_onoredC:
    s_barrier
    s_mov_b32 m0, s73
    s_add_u32 s73, s73, 1024
    buffer_load_dwordx4 v26, s[52:55], s64 offen  lds
    s_add_u32 s64, s64, 20480
    s_mov_b32 m0, s73
    s_add_u32 s73, s73, 1024
    buffer_load_dwordx4 v26, s[52:55], s64 offen  lds
    s_add_u32 s64, s64, 61440
    s_mov_b32 m0, s73
    s_add_u32 s73, s73, 1024
    buffer_load_dwordx4 v26, s[52:55], s64 offen  lds
    s_add_u32 s64, s64, 20480
    s_mov_b32 m0, s73
    s_add_u32 s73, s73, 1024
    buffer_load_dwordx4 v26, s[52:55], s64 offen  lds
    s_add_u32 s64, s64, 61440
    v_lshrrev_b32 v7, 4, v1
    v_bfe_u32 v8, v1, 2, 2
    v_and_b32 v9, 3, v1
    v_and_b32 v10, 15, v1
    v_and_b32 v12, 1, v7
    v_lshl_add_u32 v11, v12, 2, v8
    v_lshrrev_b32 v12, 1, v7
    v_lshl_add_u32 v11, v12, 4, v11
    v_lshlrev_b32 v11, 5, v11
    v_lshl_add_u32 v11, v9, 3, v11
    v_add_u32 v13, s72, v11
    v_bfe_u32 v11, v1, 3, 1
    v_mul_u32_u24 v11, 1280, v11
    v_and_b32 v12, 7, v1
    v_lshl_add_u32 v11, v12, 2, v11
    v_add_u32 v18, s71, v11
    v_lshlrev_b32 v14, 7, v9
    v_and_b32 v12, 1, v8
    v_lshl_add_u32 v14, v12, 6, v14
    v_lshl_add_u32 v14, v7, 4, v14
    s_mul_i32 s71, s3, 3
    s_lshr_b32 s74, s71, 1
    s_and_b32 s4, s71, 1
    s_lshl2_add_u32 s4, s74, s4
    s_lshl_b32 s4, s4, 12
    s_add_u32 s4, s4, 691200
    s_add_u32 s71, s71, 1
    s_lshr_b32 s74, s71, 1
    s_and_b32 s5, s71, 1
    s_lshl2_add_u32 s5, s74, s5
    s_lshl_b32 s5, s5, 12
    s_add_u32 s5, s5, 691200
    s_add_u32 s71, s71, 1
    s_lshr_b32 s74, s71, 1
    s_and_b32 s6, s71, 1
    s_lshl2_add_u32 s6, s74, s6
    s_lshl_b32 s6, s6, 12
    s_add_u32 s6, s6, 691200
    s_add_u32 s71, s71, 1
    s_mov_b32 s71, s38
    v_lshl_add_u32 v15, v7, 4, s71
    v_lshl_add_u32 v15, v8, 7, v15
    v_and_b32 v12, 1, v1
    v_lshl_add_u32 v15, v12, 6, v15
    v_bfe_u32 v12, v1, 1, 1
    v_lshl_add_u32 v15, v12, 9, v15
    v_mov_b32 v24, 0xffff
    v_mov_b32 v25, 0xffff0000
    s_lshr_b32 s71, s76, 1
    s_lshr_b32 s74, s71, 1
    s_and_b32 s71, s71, 1
    s_lshl2_add_u32 s71, s74, s71
    s_lshl_b32 s71, s71, 12
    s_add_u32 s71, s71, 527360
    s_add_u32 s71, s71, s38
    s_lshl_b32 s74, s3, 9
    s_add_u32 s71, s71, s74
    v_add_u32 v14, s71, v14
    s_lshl_b32 s71, s3, 7
    s_add_u32 s71, s71, 16960
    v_lshl_add_u32 v16, v1, 2, s71
    v_lshlrev_b32 v17, 3, v1
    v_add_u32 v17, 16960, v17
    s_and_b32 s71, s76, 1
    s_lshl_b32 s71, s71, 1
    v_bfe_u32 v11, v1, 3, 1
    v_add_u32 v11, s71, v11
    v_cmp_eq_u32 vcc, v11, v7
    v_mov_b32 v12, 0x3f803f80
    s_nop 0
    v_cndmask_b32 v12, 0, v12, vcc
    v_and_b32 v20, v12, v3
    v_and_b32 v21, v12, v4
    v_and_b32 v22, v12, v5
    v_and_b32 v23, v12, v6
    v_mov_b32 v56, v18
    v_mov_b32 v18, 1073741824
    s_mov_b32 s69, 1
    s_branch L_postC
L_realC:
    s_mov_b64 exec, -1
    v_mov_b32 v18, v56
    s_mov_b32 s69, 0
    s_mov_b32 m0, s73
    s_add_u32 s73, s73, 1024
    buffer_load_dwordx4 v26, s[52:55], s64 offen  lds
    s_add_u32 s64, s64, 20480
    s_mov_b32 m0, s73
    s_add_u32 s73, s73, 1024
    buffer_load_dwordx4 v26, s[52:55], s64 offen  lds
    s_add_u32 s64, s64, 61440
    s_waitcnt vmcnt(6)
    ds_read_b64_tr_b16 v[64:65], v13 offset:0
    ds_read_b64_tr_b16 v[66:67], v13 offset:256
    ds_read_b64_tr_b16 v[68:69], v13 offset:1024
    ds_read_b64_tr_b16 v[70:71], v13 offset:1280
    s_mov_b32 m0, s73
    s_add_u32 s73, s73, 1024
    buffer_load_dwordx4 v26, s[52:55], s64 offen  lds
    s_add_u32 s64, s64, 20480
    s_mov_b32 m0, s73
    s_add_u32 s73, s73, 1024
    buffer_load_dwordx4 v26, s[52:55], s64 offen  lds
    s_add_u32 s64, s64, 61440
    s_waitcnt vmcnt(6)
    ds_read_b64_tr_b16 v[72:73], v13 offset:2048
    ds_read_b64_tr_b16 v[74:75], v13 offset:2304
    ds_read_b64_tr_b16 v[76:77], v13 offset:3072
    ds_read_b64_tr_b16 v[78:79], v13 offset:3328
    s_mov_b32 m0, s73
    s_add_u32 s73, s73, 1024
    buffer_load_dwordx4 v26, s[52:55], s64 offen  lds
    s_add_u32 s64, s64, 20480
    s_mov_b32 m0, s73
    s_add_u32 s73, s73, 1024
    buffer_load_dwordx4 v26, s[52:55], s64 offen  lds
    s_add_u32 s64, s64, 61440
    s_waitcnt vmcnt(6)
    ds_read_b64_tr_b16 v[80:81], v13 offset:4096
    ds_read_b64_tr_b16 v[82:83], v13 offset:4352
    ds_read_b64_tr_b16 v[84:85], v13 offset:5120
    ds_read_b64_tr_b16 v[86:87], v13 offset:5376
    s_waitcnt vmcnt(4)
    ds_read_b64_tr_b16 v[88:89], v13 offset:6144
    ds_read_b64_tr_b16 v[90:91], v13 offset:6400
    ds_read_b64_tr_b16 v[92:93], v13 offset:7168
    ds_read_b64_tr_b16 v[94:95], v13 offset:7424
    s_waitcnt vmcnt(2)
    ds_read_b64_tr_b16 v[96:97], v13 offset:8192
    ds_read_b64_tr_b16 v[98:99], v13 offset:8448
    ds_read_b64_tr_b16 v[100:101], v13 offset:9216
    ds_read_b64_tr_b16 v[102:103], v13 offset:9472
    s_waitcnt vmcnt(0)
    ds_read_b64_tr_b16 v[104:105], v13 offset:10240
    ds_read_b64_tr_b16 v[106:107], v13 offset:10496
    ds_read_b64_tr_b16 v[108:109], v13 offset:11264
    ds_read_b64_tr_b16 v[110:111], v13 offset:11520
    v_mov_b32 v19, 0
    s_waitcnt lgkmcnt(0)
    s_cmp_ge_u32 s3, 2
    s_cbranch_scc1 L_cnores
    s_mov_b32 s75, 0
    s_mov_b32 exec_lo, 0xff00ff
    s_mov_b32 exec_hi, 0xff00ff
L_poll4:
    buffer_load_dwordx4 v[32:35], v14, s[44:47], 0 offen sc1
    s_add_u32 s75, s75, 1
L_pchk4:
    s_waitcnt vmcnt(0)
    v_max3_u32 v11, v32, v33, v34
    v_max_u32 v11, v11, v35
    v_cmp_eq_u32 vcc, -1, v11
    s_cbranch_vccz L_pok4
    s_mov_b64 exec, vcc
    s_cmp_lt_u32 s75, 4194304
    s_cbranch_scc1 L_poll4
L_pok4:
    s_mov_b64 exec, -1
    v_mfma_f32_16x16x32_bf16 v[160:163], v[32:35], v[20:23], 0
    s_nop 7
    v_add_f32 v19, v160, v161
    v_add_f32 v11, v162, v163
    v_add_f32 v19, v19, v11
L_cnores:
    s_mov_b32 s75, 0
    buffer_load_dwordx4 v[32:35], v15, s[44:47], s4 offen sc1
    buffer_load_dwordx4 v[36:39], v15, s[44:47], s5 offen sc1
    buffer_load_dwordx4 v[40:43], v15, s[44:47], s6 offen sc1
    s_branch L_pchk5
    .p2align 7
    s_endpgm
    s_endpgm
    s_endpgm
    s_endpgm
    s_endpgm
    s_endpgm
    s_endpgm
L_poll5:
    s_mov_b64 exec, s[12:13]
    buffer_load_dwordx4 v[32:35], v15, s[44:47], s4 offen sc1
    s_mov_b64 exec, s[14:15]
    buffer_load_dwordx4 v[36:39], v15, s[44:47], s5 offen sc1
    s_mov_b64 exec, s[16:17]
    buffer_load_dwordx4 v[40:43], v15, s[44:47], s6 offen sc1
    s_add_u32 s75, s75, 1
    s_mov_b64 exec, -1
    s_cmp_ge_u32 s75, 4194304
    s_cbranch_scc1 L_pok5
L_pchk5:
    s_waitcnt vmcnt(2)
    v_max3_u32 v11, v32, v33, v34
    v_max_u32 v11, v11, v35
    v_cmp_eq_u32 s[12:13], -1, v11
    s_waitcnt vmcnt(1)
    v_max3_u32 v12, v36, v37, v38
    v_max_u32 v12, v12, v39
    v_cmp_eq_u32 s[14:15], -1, v12
    s_waitcnt vmcnt(0)
    v_max3_u32 v11, v40, v41, v42
    v_max_u32 v11, v11, v43
    s_or_b64 s[58:59], s[12:13], s[14:15]
    v_cmp_eq_u32 s[16:17], -1, v11
    s_or_b64 s[58:59], s[58:59], s[16:17]
    s_cbranch_scc1 L_poll5
L_pok5:
L_postC:
    v_and_b32_dpp v176, v32, v24 row_ror:8 row_mask:0xf bank_mask:0xf
    v_and_b32_dpp v177, v32, v25 row_ror:8 row_mask:0xf bank_mask:0xf
    v_and_b32_dpp v178, v33, v24 row_ror:8 row_mask:0xf bank_mask:0xf
    v_and_b32_dpp v179, v33, v25 row_ror:8 row_mask:0xf bank_mask:0xf
    v_and_b32_dpp v180, v34, v24 row_ror:8 row_mask:0xf bank_mask:0xf
    v_and_b32_dpp v181, v34, v25 row_ror:8 row_mask:0xf bank_mask:0xf
    v_and_b32_dpp v182, v35, v24 row_ror:8 row_mask:0xf bank_mask:0xf
    v_and_b32_dpp v183, v35, v25 row_ror:8 row_mask:0xf bank_mask:0xf
    v_dot2_f32_bf16 v176, v176, v32, 0
    v_dot2_f32_bf16 v177, v177, v32, 0
    v_dot2_f32_bf16 v178, v178, v33, 0
    v_dot2_f32_bf16 v179, v179, v33, 0
    v_dot2_f32_bf16 v180, v180, v34, 0
    v_dot2_f32_bf16 v181, v181, v34, 0
    v_dot2_f32_bf16 v182, v182, v35, 0
    v_dot2_f32_bf16 v183, v183, v35, 0
    v_cvt_pk_bf16_f32 v184, v176, v177
    v_cvt_pk_bf16_f32 v185, v178, v179
    v_cvt_pk_bf16_f32 v186, v180, v181
    v_cvt_pk_bf16_f32 v187, v182, v183
    v_and_b32_dpp v176, v36, v24 row_ror:8 row_mask:0xf bank_mask:0xf
    v_and_b32_dpp v177, v36, v25 row_ror:8 row_mask:0xf bank_mask:0xf
    v_and_b32_dpp v178, v37, v24 row_ror:8 row_mask:0xf bank_mask:0xf
    v_and_b32_dpp v179, v37, v25 row_ror:8 row_mask:0xf bank_mask:0xf
    v_mfma_f32_16x16x32_bf16 v[160:163], v[184:187], v[64:67], 0
    v_and_b32_dpp v180, v38, v24 row_ror:8 row_mask:0xf bank_mask:0xf
    v_and_b32_dpp v181, v38, v25 row_ror:8 row_mask:0xf bank_mask:0xf
    v_mfma_f32_16x16x32_bf16 v[164:167], v[184:187], v[68:71], 0
    v_and_b32_dpp v182, v39, v24 row_ror:8 row_mask:0xf bank_mask:0xf
    v_and_b32_dpp v183, v39, v25 row_ror:8 row_mask:0xf bank_mask:0xf
    v_mfma_f32_16x16x32_bf16 v[168:171], v[184:187], v[72:75], 0
    v_dot2_f32_bf16 v176, v176, v36, 0
    v_dot2_f32_bf16 v177, v177, v36, 0
    v_mfma_f32_16x16x32_bf16 v[172:175], v[184:187], v[76:79], 0
    v_dot2_f32_bf16 v178, v178, v37, 0
    v_dot2_f32_bf16 v179, v179, v37, 0
    v_dot2_f32_bf16 v180, v180, v38, 0
    v_dot2_f32_bf16 v181, v181, v38, 0
    v_dot2_f32_bf16 v182, v182, v39, 0
    v_dot2_f32_bf16 v183, v183, v39, 0
    v_cvt_pk_bf16_f32 v188, v176, v177
    v_cvt_pk_bf16_f32 v189, v178, v179
    v_cvt_pk_bf16_f32 v190, v180, v181
    v_cvt_pk_bf16_f32 v191, v182, v183
    v_and_b32_dpp v176, v40, v24 row_ror:8 row_mask:0xf bank_mask:0xf
    v_and_b32_dpp v177, v40, v25 row_ror:8 row_mask:0xf bank_mask:0xf
    v_and_b32_dpp v178, v41, v24 row_ror:8 row_mask:0xf bank_mask:0xf
    v_and_b32_dpp v179, v41, v25 row_ror:8 row_mask:0xf bank_mask:0xf
    v_mfma_f32_16x16x32_bf16 v[160:163], v[188:191], v[80:83], v[160:163]
    v_and_b32_dpp v180, v42, v24 row_ror:8 row_mask:0xf bank_mask:0xf
    v_and_b32_dpp v181, v42, v25 row_ror:8 row_mask:0xf bank_mask:0xf
    v_mfma_f32_16x16x32_bf16 v[164:167], v[188:191], v[84:87], v[164:167]
    v_and_b32_dpp v182, v43, v24 row_ror:8 row_mask:0xf bank_mask:0xf
    v_and_b32_dpp v183, v43, v25 row_ror:8 row_mask:0xf bank_mask:0xf
    v_mfma_f32_16x16x32_bf16 v[168:171], v[188:191], v[88:91], v[168:171]
    v_dot2_f32_bf16 v176, v176, v40, 0
    v_dot2_f32_bf16 v177, v177, v40, 0
    v_mfma_f32_16x16x32_bf16 v[172:175], v[188:191], v[92:95], v[172:175]
    v_dot2_f32_bf16 v178, v178, v41, 0
    v_dot2_f32_bf16 v179, v179, v41, 0
    v_dot2_f32_bf16 v180, v180, v42, 0
    v_dot2_f32_bf16 v181, v181, v42, 0
    v_dot2_f32_bf16 v182, v182, v43, 0
    v_dot2_f32_bf16 v183, v183, v43, 0
    v_cvt_pk_bf16_f32 v192, v176, v177
    v_cvt_pk_bf16_f32 v193, v178, v179
    v_cvt_pk_bf16_f32 v194, v180, v181
    v_cvt_pk_bf16_f32 v195, v182, v183
    s_nop 1
    v_mfma_f32_16x16x32_bf16 v[160:163], v[192:195], v[96:99], v[160:163]
    v_mfma_f32_16x16x32_bf16 v[164:167], v[192:195], v[100:103], v[164:167]
    v_mfma_f32_16x16x32_bf16 v[168:171], v[192:195], v[104:107], v[168:171]
    v_mfma_f32_16x16x32_bf16 v[172:175], v[192:195], v[108:111], v[172:175]
    s_mov_b32 exec_lo, 0xffffffff
    s_mov_b32 exec_hi, 0x0
    s_nop 2
    v_add_f32 v19, v19, v160
    v_add_f32 v19, v19, v165
    v_add_f32 v19, v19, v170
    v_add_f32 v19, v19, v175
    ds_write_b32 v16, v19
    s_mov_b64 exec, -1
    s_waitcnt lgkmcnt(0)
    s_barrier
    s_cmp_lg_u32 s3, 0
    s_cbranch_scc1 L_finC
    s_mov_b32 exec_lo, 0xffff
    s_mov_b32 exec_hi, 0x0
    ds_read2_b64 v[200:203], v17 offset0:0 offset1:16
    ds_read2_b64 v[204:207], v17 offset0:32 offset1:48
    s_waitcnt lgkmcnt(1)
    v_pk_add_f32 v[200:201], v[200:201], v[202:203]
    s_waitcnt lgkmcnt(0)
    v_pk_add_f32 v[204:205], v[204:205], v[206:207]
    v_pk_add_f32 v[200:201], v[200:201], v[204:205]
    v_cvt_pk_bf16_f32 v200, v200, v201
    buffer_store_dword v200, v18, s[60:63], 0 offen
L_finC:
    s_cmp_eq_u32 s69, 1
    s_cbranch_scc1 L_realC
L_end:
L_done:
    s_endpgm
.section .rodata,"a"
.p2align 6
.amdhsa_kernel sequential_preLN__mha_block_cached__glu_gated_glu__decode_kernel
  .amdhsa_next_free_vgpr 512
  .amdhsa_next_free_sgpr 102
  .amdhsa_accum_offset 256
  .amdhsa_group_segment_fixed_size 0
  .amdhsa_kernarg_size 96
  .amdhsa_user_sgpr_count 2
  .amdhsa_user_sgpr_kernarg_segment_ptr 1
  .amdhsa_system_sgpr_workgroup_id_x 1
.end_amdhsa_kernel
```
